```python
import torch

def _softmax(x, axis=-1):
    return torch.softmax(x, dim=axis)
def _gelu(x):
    return torch.nn.functional.gelu(x, approximate="tanh")
def _silu(x):
    return torch.nn.functional.silu(x)
def _sigmoid(x):
    return torch.sigmoid(x)
def _layernorm(x, axis=-1, eps=1e-5):
    m = x.mean(dim=axis, keepdim=True)
    v = x.var(dim=axis, keepdim=True, unbiased=False)
    return (x - m) / torch.sqrt(v + eps)
def _scatter_add(tgt, idx, src, axis=0):
    return tgt.clone().index_add_(axis, idx, src)
def _segment_sum(src, seg, n):
    out = torch.zeros((n,) + src.shape[1:], dtype=src.dtype)
    return out.index_add_(0, seg, src)
def _pad(x, pw):
    flat = tuple(v for pair in reversed(pw) for v in pair)
    return torch.nn.functional.pad(x, flat)

kernel_name = 'gated_mix__mha_block__sliding_block__prompt'

def setup_inputs():

    _w = (lambda a: (lambda t: t.to(torch.bfloat16) if t.is_floating_point() else t)(torch.as_tensor(a)))
    def _A_setup():
        B, S, D, H = 1, 2048, 640, 32
        return {
            "x": _w((lambda *s: torch.randn(*s, dtype=torch.bfloat16) * 0.05)(B, S, D)),
            "wqkv": _w((lambda *s: torch.randn(*s, dtype=torch.bfloat16) * 3.2)(D, 3 * D)),
            "wo": _w((lambda *s: torch.randn(*s, dtype=torch.bfloat16) * 0.1)(D, D)),
        }
    _A_in = _A_setup()

    def _B_setup():
        B, S, D = 1, 2048, 640
        return {
            "x": _w((lambda *s: torch.randn(*s, dtype=torch.bfloat16) * 0.05)(B, S, D)),
            "wqkv": _w((lambda *s: torch.randn(*s, dtype=torch.bfloat16) * 3.2)(D, 3 * D)),
            "wo": _w((lambda *s: torch.randn(*s, dtype=torch.bfloat16) * 0.1)(D, D)),
        }
    _B_in = _B_setup()

    return {
        "A_x": _A_in["x"],
        "A_wqkv": _A_in["wqkv"],
        "A_wo": _A_in["wo"],
        "B_x": _B_in["x"],
        "B_wqkv": _B_in["wqkv"],
        "B_wo": _B_in["wo"],
        "gate_w": _w((lambda *s: torch.randn(*s, dtype=torch.bfloat16) * 0.05)(640) * 16.0),
    }

def reference(A_x, A_wqkv, A_wo, B_x, B_wqkv, B_wo, gate_w):
    def _A_ref(x, wqkv, wo):
        B, S, D = x.shape
        H = 32
        Dh = D // H
        qkv = (lambda x, *d: x.permute(*d))((x @ wqkv).reshape(B, S, 3, H, Dh), 2, 0, 3, 1, 4)
        q, k, v = qkv[0], qkv[1], qkv[2]
        scores = torch.einsum("bhqd,bhkd->bhqk", q, k) * (Dh ** -0.5)
        p = _softmax(scores, axis=-1)
        o = torch.einsum("bhqk,bhkd->bhqd", p, v)
        return (lambda x, *d: x.permute(*d))(o, 0, 2, 1, 3).reshape(B, S, D) @ wo

    def _B_ref(x, wqkv, wo):
        B, S, D = x.shape
        H = 32; Dh = D // H; W = 256
        qkv = (lambda x, *d: x.permute(*d))((x @ wqkv).reshape(B, S, 3, H, Dh), 2, 0, 3, 1, 4)
        q, k, v = qkv[0], qkv[1], qkv[2]
        scores = torch.einsum("bhqd,bhkd->bhqk", q, k) * (Dh ** -0.5)
        idx = torch.arange(S)
        mask = (idx[:, None] - idx[None, :] >= 0) & (idx[:, None] - idx[None, :] < W)
        scores = torch.where(mask[None, None], scores, -1e9)
        p = _softmax(scores, axis=-1)
        o = torch.einsum("bhqk,bhkd->bhqd", p, v)
        return (lambda x, *d: x.permute(*d))(o, 0, 2, 1, 3).reshape(B, S, D) @ wo

    x = A_x
    g = _sigmoid((x * gate_w).sum(-1, keepdims=True))
    a = _A_ref(x, A_wqkv, A_wo)
    b = _B_ref(x, B_wqkv, B_wo)
    return g * a + (1 - g) * b
```

```asm
; @launch kernel=qkv_kernel grid=(512,1,1) block=(256,1,1) lds=65536
; @launch kernel=attn_kernel grid=(256,1,1) block=(1024,1,1) lds=147456
; @launch kernel=oproj_kernel grid=(320,1,1) block=(512,1,1) lds=77824
.amdgcn_target "amdgcn-amd-amdhsa--gfx950"
.text
.globl qkv_kernel
.p2align 8
.type qkv_kernel,@function
qkv_kernel:
    s_cmp_ge_u32 s2, 512
    s_cbranch_scc1 k1_exit
    s_load_dwordx2 s[4:5], s[0:1], 0
    s_load_dwordx2 s[6:7], s[0:1], 8
    s_load_dwordx2 s[8:9], s[0:1], 32
    s_load_dwordx2 s[10:11], s[0:1], 72
    s_load_dwordx2 s[36:37], s[0:1], 48
    s_waitcnt lgkmcnt(0)
    s_mov_b32 s12, s4
    s_and_b32 s13, s5, 0xffff
    s_mov_b32 s14, 0x280000
    s_mov_b32 s15, 0x00020000
    s_mov_b32 s20, s10
    s_and_b32 s21, s11, 0xffff
    s_mov_b32 s22, 0x10000000
    s_mov_b32 s23, 0x00020000
    s_cmp_ge_u32 s2, 480
    s_cbranch_scc1 k1_gate
    s_and_b32 s24, s2, 7
    s_lshr_b32 s25, s2, 3
    s_lshr_b32 s26, s24, 1
    s_mul_i32 s26, s26, 60
    s_add_u32 s26, s26, s25
    s_and_b32 s24, s24, 1
    s_lshl_b32 s24, s24, 3
    s_and_b32 s27, s26, 7
    s_add_u32 s24, s24, s27
    s_lshr_b32 s25, s26, 3
    s_mul_i32 s26, s25, 205
    s_lshr_b32 s26, s26, 10
    s_mul_i32 s27, s26, 5
    s_sub_u32 s27, s25, s27
    s_lshl_b32 s27, s27, 7
    s_cmp_ge_u32 s26, 3
    s_cselect_b32 s6, s8, s6
    s_cselect_b32 s7, s9, s7
    s_cselect_b32 s31, 3, 0
    s_sub_u32 s31, s26, s31
    s_mov_b32 s16, s6
    s_and_b32 s17, s7, 0xffff
    s_mov_b32 s18, 0x258000
    s_mov_b32 s19, 0x00020000
    s_mul_i32 s32, s31, 640
    s_add_u32 s32, s32, s27
    v_lshrrev_b32 v1, 6, v0
    s_nop 0
    v_readfirstlane_b32 s28, v1
    s_nop 1
    s_and_b32 s29, s28, 1
    s_lshr_b32 s30, s28, 1
    v_and_b32 v12, 63, v0
    v_and_b32 v13, 31, v12
    v_lshrrev_b32 v14, 5, v12
    v_lshrrev_b32 v4, 4, v12
    v_lshrrev_b32 v2, 2, v12
    s_movk_i32 s34, 1280
    v_mul_lo_u32 v2, v2, s34
    v_and_b32 v3, 3, v12
    v_xor_b32 v3, v3, v4
    v_lshl_add_u32 v2, v3, 4, v2
    s_movk_i32 s34, 3840
    v_mul_lo_u32 v3, v4, s34
    v_and_b32 v5, 15, v12
    v_lshlrev_b32 v6, 2, v4
    v_xor_b32 v5, v5, v6
    v_lshl_add_u32 v3, v5, 4, v3
    s_lshl_b32 s34, s32, 1
    v_add_u32 v3, s34, v3
    s_lshl_b32 s33, s24, 7
    s_lshl_b32 s34, s28, 5
    s_add_u32 s34, s34, s33
    s_mul_i32 s40, s34, 1280
    s_add_u32 s41, s40, 20480
    s_lshl_b32 s34, s28, 3
    s_mul_i32 s42, s34, 3840
    s_add_u32 s43, s42, 15360
    s_lshl_b32 s46, s28, 11
    s_lshl_b32 s34, s29, 6
    v_add_u32 v8, s34, v13
    v_bfe_u32 v9, v8, 2, 2
    v_xor_b32 v9, v9, v14
    v_lshlrev_b32 v8, 6, v8
    v_lshl_add_u32 v10, v9, 4, v8
    v_xor_b32 v9, 2, v9
    v_lshl_add_u32 v11, v9, 4, v8
    v_mov_b32 v8, v10
    v_mov_b32 v9, v11
    v_and_b32 v15, 15, v12
    v_lshrrev_b32 v10, 2, v15
    v_lshlrev_b32 v5, 6, v10
    v_lshl_add_u32 v10, v14, 3, v10
    v_lshlrev_b32 v10, 8, v10
    v_bfe_u32 v11, v12, 4, 1
    v_lshlrev_b32 v11, 5, v11
    v_and_b32 v15, 3, v15
    v_lshl_add_u32 v11, v15, 3, v11
    s_lshl_b32 s34, s30, 7
    v_add_u32 v11, s34, v11
    v_xor_b32 v6, v11, v5
    v_add_u32 v6, v6, v10
    v_add_u32 v6, 8192, v6
    v_add_u32 v11, 64, v11
    v_xor_b32 v7, v11, v5
    v_add_u32 v7, v7, v10
    v_add_u32 v7, 8192, v7
    s_cmp_eq_u32 s31, 2
    s_nop 0
    s_cbranch_scc1 k1_vpath
    v_mov_b32 v64, 0
    v_mov_b32 v65, 0
    v_mov_b32 v66, 0
    v_mov_b32 v67, 0
    v_mov_b32 v68, 0
    v_mov_b32 v69, 0
    v_mov_b32 v70, 0
    v_mov_b32 v71, 0
    v_mov_b32 v72, 0
    v_mov_b32 v73, 0
    v_mov_b32 v74, 0
    v_mov_b32 v75, 0
    v_mov_b32 v76, 0
    v_mov_b32 v77, 0
    v_mov_b32 v78, 0
    v_mov_b32 v79, 0
    v_mov_b32 v80, 0
    v_mov_b32 v81, 0
    v_mov_b32 v82, 0
    v_mov_b32 v83, 0
    v_mov_b32 v84, 0
    v_mov_b32 v85, 0
    v_mov_b32 v86, 0
    v_mov_b32 v87, 0
    v_mov_b32 v88, 0
    v_mov_b32 v89, 0
    v_mov_b32 v90, 0
    v_mov_b32 v91, 0
    v_mov_b32 v92, 0
    v_mov_b32 v93, 0
    v_mov_b32 v94, 0
    v_mov_b32 v95, 0
    v_mov_b32 v96, 0
    v_mov_b32 v97, 0
    v_mov_b32 v98, 0
    v_mov_b32 v99, 0
    v_mov_b32 v100, 0
    v_mov_b32 v101, 0
    v_mov_b32 v102, 0
    v_mov_b32 v103, 0
    v_mov_b32 v104, 0
    v_mov_b32 v105, 0
    v_mov_b32 v106, 0
    v_mov_b32 v107, 0
    v_mov_b32 v108, 0
    v_mov_b32 v109, 0
    v_mov_b32 v110, 0
    v_mov_b32 v111, 0
    v_mov_b32 v112, 0
    v_mov_b32 v113, 0
    v_mov_b32 v114, 0
    v_mov_b32 v115, 0
    v_mov_b32 v116, 0
    v_mov_b32 v117, 0
    v_mov_b32 v118, 0
    v_mov_b32 v119, 0
    v_mov_b32 v120, 0
    v_mov_b32 v121, 0
    v_mov_b32 v122, 0
    v_mov_b32 v123, 0
    v_mov_b32 v124, 0
    v_mov_b32 v125, 0
    v_mov_b32 v126, 0
    v_mov_b32 v127, 0
    s_add_u32 m0, s46, 0
    s_nop 0
    buffer_load_dwordx4 v2, s[12:15], s40 offen lds
    s_add_u32 m0, s46, 1024
    s_nop 0
    buffer_load_dwordx4 v2, s[12:15], s41 offen lds
    s_add_u32 m0, s46, 8192
    s_nop 0
    buffer_load_dwordx4 v3, s[16:19], s42 offen lds
    s_add_u32 m0, s46, 9216
    s_nop 0
    buffer_load_dwordx4 v3, s[16:19], s43 offen lds
    s_add_u32 s40, s40, 64
    s_add_u32 s42, s42, 122880
    s_add_u32 s41, s41, 64
    s_add_u32 s43, s43, 122880
    s_add_u32 m0, s46, 16384
    s_nop 0
    buffer_load_dwordx4 v2, s[12:15], s40 offen lds
    s_add_u32 m0, s46, 17408
    s_nop 0
    buffer_load_dwordx4 v2, s[12:15], s41 offen lds
    s_add_u32 m0, s46, 24576
    s_nop 0
    buffer_load_dwordx4 v3, s[16:19], s42 offen lds
    s_add_u32 m0, s46, 25600
    s_nop 0
    buffer_load_dwordx4 v3, s[16:19], s43 offen lds
    s_add_u32 s40, s40, 64
    s_add_u32 s42, s42, 122880
    s_add_u32 s41, s41, 64
    s_add_u32 s43, s43, 122880
    s_add_u32 m0, s46, 32768
    s_nop 0
    buffer_load_dwordx4 v2, s[12:15], s40 offen lds
    s_add_u32 m0, s46, 33792
    s_nop 0
    buffer_load_dwordx4 v2, s[12:15], s41 offen lds
    s_add_u32 m0, s46, 40960
    s_nop 0
    buffer_load_dwordx4 v3, s[16:19], s42 offen lds
    s_add_u32 m0, s46, 41984
    s_nop 0
    buffer_load_dwordx4 v3, s[16:19], s43 offen lds
    s_add_u32 s40, s40, 64
    s_add_u32 s42, s42, 122880
    s_add_u32 s41, s41, 64
    s_add_u32 s43, s43, 122880
    s_waitcnt vmcnt(4)
    s_barrier
    ds_read_b128 v[128:131], v8 offset:0
    ds_read_b128 v[132:135], v8 offset:2048
    ds_read_b64_tr_b16 v[136:137], v6 offset:0
    ds_read_b64_tr_b16 v[138:139], v6 offset:1024
    ds_read_b64_tr_b16 v[140:141], v7 offset:0
    ds_read_b64_tr_b16 v[142:143], v7 offset:1024
    ds_read_b128 v[144:147], v9 offset:0
    ds_read_b128 v[148:151], v9 offset:2048
    ds_read_b64_tr_b16 v[152:153], v6 offset:4096
    ds_read_b64_tr_b16 v[154:155], v6 offset:5120
    ds_read_b64_tr_b16 v[156:157], v7 offset:4096
    ds_read_b64_tr_b16 v[158:159], v7 offset:5120
    s_mov_b32 s45, 0
k1_loop_qk:
    s_add_u32 m0, s46, 49152
    s_nop 0
    buffer_load_dwordx4 v2, s[12:15], s40 offen lds
    s_add_u32 m0, s46, 50176
    s_nop 0
    buffer_load_dwordx4 v2, s[12:15], s41 offen lds
    s_add_u32 m0, s46, 57344
    s_nop 0
    buffer_load_dwordx4 v3, s[16:19], s42 offen lds
    s_add_u32 m0, s46, 58368
    s_nop 0
    buffer_load_dwordx4 v3, s[16:19], s43 offen lds
    s_add_u32 s40, s40, 64
    s_add_u32 s42, s42, 122880
    s_add_u32 s41, s41, 64
    s_add_u32 s43, s43, 122880
    s_waitcnt lgkmcnt(0)
    ds_read_b128 v[160:163], v8 offset:16384
    ds_read_b128 v[164:167], v8 offset:18432
    ds_read_b64_tr_b16 v[168:169], v6 offset:16384
    ds_read_b64_tr_b16 v[170:171], v6 offset:17408
    ds_read_b64_tr_b16 v[172:173], v7 offset:16384
    ds_read_b64_tr_b16 v[174:175], v7 offset:17408
    ds_read_b128 v[176:179], v9 offset:16384
    ds_read_b128 v[180:183], v9 offset:18432
    ds_read_b64_tr_b16 v[184:185], v6 offset:20480
    ds_read_b64_tr_b16 v[186:187], v6 offset:21504
    ds_read_b64_tr_b16 v[188:189], v7 offset:20480
    ds_read_b64_tr_b16 v[190:191], v7 offset:21504
    v_mfma_f32_32x32x16_bf16 v[64:79], v[136:139], v[128:131], v[64:79]
    v_mfma_f32_32x32x16_bf16 v[80:95], v[140:143], v[128:131], v[80:95]
    v_mfma_f32_32x32x16_bf16 v[96:111], v[136:139], v[132:135], v[96:111]
    v_mfma_f32_32x32x16_bf16 v[112:127], v[140:143], v[132:135], v[112:127]
    v_mfma_f32_32x32x16_bf16 v[64:79], v[152:155], v[144:147], v[64:79]
    v_mfma_f32_32x32x16_bf16 v[80:95], v[156:159], v[144:147], v[80:95]
    v_mfma_f32_32x32x16_bf16 v[96:111], v[152:155], v[148:151], v[96:111]
    v_mfma_f32_32x32x16_bf16 v[112:127], v[156:159], v[148:151], v[112:127]
    s_waitcnt vmcnt(4)
    s_barrier
    s_add_u32 m0, s46, 0
    s_nop 0
    buffer_load_dwordx4 v2, s[12:15], s40 offen lds
    s_add_u32 m0, s46, 1024
    s_nop 0
    buffer_load_dwordx4 v2, s[12:15], s41 offen lds
    s_add_u32 m0, s46, 8192
    s_nop 0
    buffer_load_dwordx4 v3, s[16:19], s42 offen lds
    s_add_u32 m0, s46, 9216
    s_nop 0
    buffer_load_dwordx4 v3, s[16:19], s43 offen lds
    s_add_u32 s40, s40, 64
    s_add_u32 s42, s42, 122880
    s_add_u32 s41, s41, 64
    s_add_u32 s43, s43, 122880
    s_waitcnt lgkmcnt(0)
    ds_read_b128 v[128:131], v8 offset:32768
    ds_read_b128 v[132:135], v8 offset:34816
    ds_read_b64_tr_b16 v[136:137], v6 offset:32768
    ds_read_b64_tr_b16 v[138:139], v6 offset:33792
    ds_read_b64_tr_b16 v[140:141], v7 offset:32768
    ds_read_b64_tr_b16 v[142:143], v7 offset:33792
    ds_read_b128 v[144:147], v9 offset:32768
    ds_read_b128 v[148:151], v9 offset:34816
    ds_read_b64_tr_b16 v[152:153], v6 offset:36864
    ds_read_b64_tr_b16 v[154:155], v6 offset:37888
    ds_read_b64_tr_b16 v[156:157], v7 offset:36864
    ds_read_b64_tr_b16 v[158:159], v7 offset:37888
    v_mfma_f32_32x32x16_bf16 v[64:79], v[168:171], v[160:163], v[64:79]
    v_mfma_f32_32x32x16_bf16 v[80:95], v[172:175], v[160:163], v[80:95]
    v_mfma_f32_32x32x16_bf16 v[96:111], v[168:171], v[164:167], v[96:111]
    v_mfma_f32_32x32x16_bf16 v[112:127], v[172:175], v[164:167], v[112:127]
    v_mfma_f32_32x32x16_bf16 v[64:79], v[184:187], v[176:179], v[64:79]
    v_mfma_f32_32x32x16_bf16 v[80:95], v[188:191], v[176:179], v[80:95]
    v_mfma_f32_32x32x16_bf16 v[96:111], v[184:187], v[180:183], v[96:111]
    v_mfma_f32_32x32x16_bf16 v[112:127], v[188:191], v[180:183], v[112:127]
    s_waitcnt vmcnt(4)
    s_barrier
    s_add_u32 m0, s46, 16384
    s_nop 0
    buffer_load_dwordx4 v2, s[12:15], s40 offen lds
    s_add_u32 m0, s46, 17408
    s_nop 0
    buffer_load_dwordx4 v2, s[12:15], s41 offen lds
    s_add_u32 m0, s46, 24576
    s_nop 0
    buffer_load_dwordx4 v3, s[16:19], s42 offen lds
    s_add_u32 m0, s46, 25600
    s_nop 0
    buffer_load_dwordx4 v3, s[16:19], s43 offen lds
    s_add_u32 s40, s40, 64
    s_add_u32 s42, s42, 122880
    s_add_u32 s41, s41, 64
    s_add_u32 s43, s43, 122880
    s_waitcnt lgkmcnt(0)
    ds_read_b128 v[160:163], v8 offset:49152
    ds_read_b128 v[164:167], v8 offset:51200
    ds_read_b64_tr_b16 v[168:169], v6 offset:49152
    ds_read_b64_tr_b16 v[170:171], v6 offset:50176
    ds_read_b64_tr_b16 v[172:173], v7 offset:49152
    ds_read_b64_tr_b16 v[174:175], v7 offset:50176
    ds_read_b128 v[176:179], v9 offset:49152
    ds_read_b128 v[180:183], v9 offset:51200
    ds_read_b64_tr_b16 v[184:185], v6 offset:53248
    ds_read_b64_tr_b16 v[186:187], v6 offset:54272
    ds_read_b64_tr_b16 v[188:189], v7 offset:53248
    ds_read_b64_tr_b16 v[190:191], v7 offset:54272
    v_mfma_f32_32x32x16_bf16 v[64:79], v[136:139], v[128:131], v[64:79]
    v_mfma_f32_32x32x16_bf16 v[80:95], v[140:143], v[128:131], v[80:95]
    v_mfma_f32_32x32x16_bf16 v[96:111], v[136:139], v[132:135], v[96:111]
    v_mfma_f32_32x32x16_bf16 v[112:127], v[140:143], v[132:135], v[112:127]
    v_mfma_f32_32x32x16_bf16 v[64:79], v[152:155], v[144:147], v[64:79]
    v_mfma_f32_32x32x16_bf16 v[80:95], v[156:159], v[144:147], v[80:95]
    v_mfma_f32_32x32x16_bf16 v[96:111], v[152:155], v[148:151], v[96:111]
    v_mfma_f32_32x32x16_bf16 v[112:127], v[156:159], v[148:151], v[112:127]
    s_waitcnt vmcnt(4)
    s_barrier
    s_add_u32 m0, s46, 32768
    s_nop 0
    buffer_load_dwordx4 v2, s[12:15], s40 offen lds
    s_add_u32 m0, s46, 33792
    s_nop 0
    buffer_load_dwordx4 v2, s[12:15], s41 offen lds
    s_add_u32 m0, s46, 40960
    s_nop 0
    buffer_load_dwordx4 v3, s[16:19], s42 offen lds
    s_add_u32 m0, s46, 41984
    s_nop 0
    buffer_load_dwordx4 v3, s[16:19], s43 offen lds
    s_add_u32 s40, s40, 64
    s_add_u32 s42, s42, 122880
    s_add_u32 s41, s41, 64
    s_add_u32 s43, s43, 122880
    s_waitcnt lgkmcnt(0)
    ds_read_b128 v[128:131], v8 offset:0
    ds_read_b128 v[132:135], v8 offset:2048
    ds_read_b64_tr_b16 v[136:137], v6 offset:0
    ds_read_b64_tr_b16 v[138:139], v6 offset:1024
    ds_read_b64_tr_b16 v[140:141], v7 offset:0
    ds_read_b64_tr_b16 v[142:143], v7 offset:1024
    ds_read_b128 v[144:147], v9 offset:0
    ds_read_b128 v[148:151], v9 offset:2048
    ds_read_b64_tr_b16 v[152:153], v6 offset:4096
    ds_read_b64_tr_b16 v[154:155], v6 offset:5120
    ds_read_b64_tr_b16 v[156:157], v7 offset:4096
    ds_read_b64_tr_b16 v[158:159], v7 offset:5120
    v_mfma_f32_32x32x16_bf16 v[64:79], v[168:171], v[160:163], v[64:79]
    v_mfma_f32_32x32x16_bf16 v[80:95], v[172:175], v[160:163], v[80:95]
    v_mfma_f32_32x32x16_bf16 v[96:111], v[168:171], v[164:167], v[96:111]
    v_mfma_f32_32x32x16_bf16 v[112:127], v[172:175], v[164:167], v[112:127]
    v_mfma_f32_32x32x16_bf16 v[64:79], v[184:187], v[176:179], v[64:79]
    v_mfma_f32_32x32x16_bf16 v[80:95], v[188:191], v[176:179], v[80:95]
    v_mfma_f32_32x32x16_bf16 v[96:111], v[184:187], v[180:183], v[96:111]
    v_mfma_f32_32x32x16_bf16 v[112:127], v[188:191], v[180:183], v[112:127]
    s_waitcnt vmcnt(4)
    s_barrier
    s_add_u32 s45, s45, 1
    s_cmp_lt_u32 s45, 5
    s_nop 7
    s_cbranch_scc1 k1_loop_qk
    s_waitcnt vmcnt(0) lgkmcnt(0)
    s_cmp_eq_u32 s31, 0
    s_mov_b32 s45, 0x3f800000
    s_cselect_b32 s45, 0x3ea52b5c, s45
    v_mul_f32 v64, s45, v64
    v_mul_f32 v65, s45, v65
    v_mul_f32 v66, s45, v66
    v_mul_f32 v67, s45, v67
    v_mul_f32 v68, s45, v68
    v_mul_f32 v69, s45, v69
    v_mul_f32 v70, s45, v70
    v_mul_f32 v71, s45, v71
    v_mul_f32 v72, s45, v72
    v_mul_f32 v73, s45, v73
    v_mul_f32 v74, s45, v74
    v_mul_f32 v75, s45, v75
    v_mul_f32 v76, s45, v76
    v_mul_f32 v77, s45, v77
    v_mul_f32 v78, s45, v78
    v_mul_f32 v79, s45, v79
    v_mul_f32 v80, s45, v80
    v_mul_f32 v81, s45, v81
    v_mul_f32 v82, s45, v82
    v_mul_f32 v83, s45, v83
    v_mul_f32 v84, s45, v84
    v_mul_f32 v85, s45, v85
    v_mul_f32 v86, s45, v86
    v_mul_f32 v87, s45, v87
    v_mul_f32 v88, s45, v88
    v_mul_f32 v89, s45, v89
    v_mul_f32 v90, s45, v90
    v_mul_f32 v91, s45, v91
    v_mul_f32 v92, s45, v92
    v_mul_f32 v93, s45, v93
    v_mul_f32 v94, s45, v94
    v_mul_f32 v95, s45, v95
    v_mul_f32 v96, s45, v96
    v_mul_f32 v97, s45, v97
    v_mul_f32 v98, s45, v98
    v_mul_f32 v99, s45, v99
    v_mul_f32 v100, s45, v100
    v_mul_f32 v101, s45, v101
    v_mul_f32 v102, s45, v102
    v_mul_f32 v103, s45, v103
    v_mul_f32 v104, s45, v104
    v_mul_f32 v105, s45, v105
    v_mul_f32 v106, s45, v106
    v_mul_f32 v107, s45, v107
    v_mul_f32 v108, s45, v108
    v_mul_f32 v109, s45, v109
    v_mul_f32 v110, s45, v110
    v_mul_f32 v111, s45, v111
    v_mul_f32 v112, s45, v112
    v_mul_f32 v113, s45, v113
    v_mul_f32 v114, s45, v114
    v_mul_f32 v115, s45, v115
    v_mul_f32 v116, s45, v116
    v_mul_f32 v117, s45, v117
    v_mul_f32 v118, s45, v118
    v_mul_f32 v119, s45, v119
    v_mul_f32 v120, s45, v120
    v_mul_f32 v121, s45, v121
    v_mul_f32 v122, s45, v122
    v_mul_f32 v123, s45, v123
    v_mul_f32 v124, s45, v124
    v_mul_f32 v125, s45, v125
    v_mul_f32 v126, s45, v126
    v_mul_f32 v127, s45, v127
    s_mov_b32 s46, 167936
    s_cselect_b32 s46, 81920, s46
    s_mov_b32 s47, 2624
    s_cselect_b32 s47, 1280, s47
    s_cmp_ge_u32 s26, 3
    s_mov_b32 s48, 12582912
    s_cselect_b32 s48, 15728640, s48
    s_mov_b32 s49, 0
    s_cselect_b32 s49, 6291456, s49
    s_cmp_eq_u32 s31, 0
    s_cselect_b32 s48, s48, s49
    s_lshl_b32 s49, s24, 2
    s_lshl_b32 s50, s29, 1
    s_add_u32 s49, s49, s50
    s_mul_i32 s49, s49, s47
    s_add_u32 s48, s48, s49
    s_add_u32 s49, s48, s47
    s_mov_b64 s[52:53], -1
    s_mov_b32 s52, 0
    s_mov_b64 s[54:55], -1
    s_mov_b32 s55, 0
    s_lshr_b32 s50, s27, 2
    s_lshl_b32 s51, s30, 4
    s_add_u32 s50, s50, s51
    s_add_u32 s56, s50, 0
    s_mul_i32 s57, s56, 205
    s_lshr_b32 s57, s57, 10
    s_mul_i32 s58, s57, 5
    s_sub_u32 s62, s56, s58
    s_mul_i32 s57, s57, s46
    s_lshr_b32 s58, s62, 1
    s_lshl_b32 s58, s58, 9
    s_and_b32 s59, s62, 1
    s_lshl_b32 s59, s59, 3
    s_add_u32 s60, s57, s58
    s_add_u32 s60, s60, s59
    s_add_u32 s61, s57, 1024
    s_add_u32 s56, s50, 1
    s_mul_i32 s57, s56, 205
    s_lshr_b32 s57, s57, 10
    s_mul_i32 s58, s57, 5
    s_sub_u32 s65, s56, s58
    s_mul_i32 s57, s57, s46
    s_lshr_b32 s58, s65, 1
    s_lshl_b32 s58, s58, 9
    s_and_b32 s59, s65, 1
    s_lshl_b32 s59, s59, 3
    s_add_u32 s63, s57, s58
    s_add_u32 s63, s63, s59
    s_add_u32 s64, s57, 1024
    s_mov_b64 s[66:67], -1
    s_cmp_eq_u32 s62, 4
    s_cselect_b64 s[66:67], s[52:53], s[66:67]
    s_cmp_eq_u32 s65, 4
    s_cselect_b64 s[66:67], s[54:55], s[66:67]
    v_mov_b32 v48, s60
    v_mov_b32 v49, s63
    v_cndmask_b32 v48, v48, v49, s[52:53]
    v_lshl_add_u32 v48, v13, 4, v48
    v_mov_b32 v50, s61
    v_mov_b32 v49, s64
    v_cndmask_b32 v50, v50, v49, s[52:53]
    v_lshl_add_u32 v50, v13, 2, v50
    v_cvt_pk_bf16_f32 v52, v64, v65
    v_cvt_pk_bf16_f32 v53, v66, v67
    v_cvt_pk_bf16_f32 v54, v96, v97
    v_cvt_pk_bf16_f32 v55, v98, v99
    s_mov_b64 exec, s[66:67]
    buffer_store_dwordx2 v[52:53], v48, s[20:23], s48 offen
    buffer_store_dwordx2 v[54:55], v48, s[20:23], s49 offen
    s_andn2_b64 exec, -1, s[66:67]
    s_cbranch_scc0 k1_s_1
    buffer_store_dword v52, v50, s[20:23], s48 offen
    buffer_store_dword v53, v50, s[20:23], s48 offen offset:128
    buffer_store_dword v54, v50, s[20:23], s49 offen
    buffer_store_dword v55, v50, s[20:23], s49 offen offset:128
k1_s_1:
    s_mov_b64 exec, -1
    s_add_u32 s56, s50, 2
    s_mul_i32 s57, s56, 205
    s_lshr_b32 s57, s57, 10
    s_mul_i32 s58, s57, 5
    s_sub_u32 s62, s56, s58
    s_mul_i32 s57, s57, s46
    s_lshr_b32 s58, s62, 1
    s_lshl_b32 s58, s58, 9
    s_and_b32 s59, s62, 1
    s_lshl_b32 s59, s59, 3
    s_add_u32 s60, s57, s58
    s_add_u32 s60, s60, s59
    s_add_u32 s61, s57, 1024
    s_add_u32 s56, s50, 3
    s_mul_i32 s57, s56, 205
    s_lshr_b32 s57, s57, 10
    s_mul_i32 s58, s57, 5
    s_sub_u32 s65, s56, s58
    s_mul_i32 s57, s57, s46
    s_lshr_b32 s58, s65, 1
    s_lshl_b32 s58, s58, 9
    s_and_b32 s59, s65, 1
    s_lshl_b32 s59, s59, 3
    s_add_u32 s63, s57, s58
    s_add_u32 s63, s63, s59
    s_add_u32 s64, s57, 1024
    s_mov_b64 s[66:67], -1
    s_cmp_eq_u32 s62, 4
    s_cselect_b64 s[66:67], s[52:53], s[66:67]
    s_cmp_eq_u32 s65, 4
    s_cselect_b64 s[66:67], s[54:55], s[66:67]
    v_mov_b32 v48, s60
    v_mov_b32 v49, s63
    v_cndmask_b32 v48, v48, v49, s[52:53]
    v_lshl_add_u32 v48, v13, 4, v48
    v_mov_b32 v50, s61
    v_mov_b32 v49, s64
    v_cndmask_b32 v50, v50, v49, s[52:53]
    v_lshl_add_u32 v50, v13, 2, v50
    v_cvt_pk_bf16_f32 v52, v68, v69
    v_cvt_pk_bf16_f32 v53, v70, v71
    v_cvt_pk_bf16_f32 v54, v100, v101
    v_cvt_pk_bf16_f32 v55, v102, v103
    s_mov_b64 exec, s[66:67]
    buffer_store_dwordx2 v[52:53], v48, s[20:23], s48 offen
    buffer_store_dwordx2 v[54:55], v48, s[20:23], s49 offen
    s_andn2_b64 exec, -1, s[66:67]
    s_cbranch_scc0 k1_s_2
    buffer_store_dword v52, v50, s[20:23], s48 offen
    buffer_store_dword v53, v50, s[20:23], s48 offen offset:128
    buffer_store_dword v54, v50, s[20:23], s49 offen
    buffer_store_dword v55, v50, s[20:23], s49 offen offset:128
k1_s_2:
    s_mov_b64 exec, -1
    s_add_u32 s56, s50, 4
    s_mul_i32 s57, s56, 205
    s_lshr_b32 s57, s57, 10
    s_mul_i32 s58, s57, 5
    s_sub_u32 s62, s56, s58
    s_mul_i32 s57, s57, s46
    s_lshr_b32 s58, s62, 1
    s_lshl_b32 s58, s58, 9
    s_and_b32 s59, s62, 1
    s_lshl_b32 s59, s59, 3
    s_add_u32 s60, s57, s58
    s_add_u32 s60, s60, s59
    s_add_u32 s61, s57, 1024
    s_add_u32 s56, s50, 5
    s_mul_i32 s57, s56, 205
    s_lshr_b32 s57, s57, 10
    s_mul_i32 s58, s57, 5
    s_sub_u32 s65, s56, s58
    s_mul_i32 s57, s57, s46
    s_lshr_b32 s58, s65, 1
    s_lshl_b32 s58, s58, 9
    s_and_b32 s59, s65, 1
    s_lshl_b32 s59, s59, 3
    s_add_u32 s63, s57, s58
    s_add_u32 s63, s63, s59
    s_add_u32 s64, s57, 1024
    s_mov_b64 s[66:67], -1
    s_cmp_eq_u32 s62, 4
    s_cselect_b64 s[66:67], s[52:53], s[66:67]
    s_cmp_eq_u32 s65, 4
    s_cselect_b64 s[66:67], s[54:55], s[66:67]
    v_mov_b32 v48, s60
    v_mov_b32 v49, s63
    v_cndmask_b32 v48, v48, v49, s[52:53]
    v_lshl_add_u32 v48, v13, 4, v48
    v_mov_b32 v50, s61
    v_mov_b32 v49, s64
    v_cndmask_b32 v50, v50, v49, s[52:53]
    v_lshl_add_u32 v50, v13, 2, v50
    v_cvt_pk_bf16_f32 v52, v72, v73
    v_cvt_pk_bf16_f32 v53, v74, v75
    v_cvt_pk_bf16_f32 v54, v104, v105
    v_cvt_pk_bf16_f32 v55, v106, v107
    s_mov_b64 exec, s[66:67]
    buffer_store_dwordx2 v[52:53], v48, s[20:23], s48 offen
    buffer_store_dwordx2 v[54:55], v48, s[20:23], s49 offen
    s_andn2_b64 exec, -1, s[66:67]
    s_cbranch_scc0 k1_s_3
    buffer_store_dword v52, v50, s[20:23], s48 offen
    buffer_store_dword v53, v50, s[20:23], s48 offen offset:128
    buffer_store_dword v54, v50, s[20:23], s49 offen
    buffer_store_dword v55, v50, s[20:23], s49 offen offset:128
k1_s_3:
    s_mov_b64 exec, -1
    s_add_u32 s56, s50, 6
    s_mul_i32 s57, s56, 205
    s_lshr_b32 s57, s57, 10
    s_mul_i32 s58, s57, 5
    s_sub_u32 s62, s56, s58
    s_mul_i32 s57, s57, s46
    s_lshr_b32 s58, s62, 1
    s_lshl_b32 s58, s58, 9
    s_and_b32 s59, s62, 1
    s_lshl_b32 s59, s59, 3
    s_add_u32 s60, s57, s58
    s_add_u32 s60, s60, s59
    s_add_u32 s61, s57, 1024
    s_add_u32 s56, s50, 7
    s_mul_i32 s57, s56, 205
    s_lshr_b32 s57, s57, 10
    s_mul_i32 s58, s57, 5
    s_sub_u32 s65, s56, s58
    s_mul_i32 s57, s57, s46
    s_lshr_b32 s58, s65, 1
    s_lshl_b32 s58, s58, 9
    s_and_b32 s59, s65, 1
    s_lshl_b32 s59, s59, 3
    s_add_u32 s63, s57, s58
    s_add_u32 s63, s63, s59
    s_add_u32 s64, s57, 1024
    s_mov_b64 s[66:67], -1
    s_cmp_eq_u32 s62, 4
    s_cselect_b64 s[66:67], s[52:53], s[66:67]
    s_cmp_eq_u32 s65, 4
    s_cselect_b64 s[66:67], s[54:55], s[66:67]
    v_mov_b32 v48, s60
    v_mov_b32 v49, s63
    v_cndmask_b32 v48, v48, v49, s[52:53]
    v_lshl_add_u32 v48, v13, 4, v48
    v_mov_b32 v50, s61
    v_mov_b32 v49, s64
    v_cndmask_b32 v50, v50, v49, s[52:53]
    v_lshl_add_u32 v50, v13, 2, v50
    v_cvt_pk_bf16_f32 v52, v76, v77
    v_cvt_pk_bf16_f32 v53, v78, v79
    v_cvt_pk_bf16_f32 v54, v108, v109
    v_cvt_pk_bf16_f32 v55, v110, v111
    s_mov_b64 exec, s[66:67]
    buffer_store_dwordx2 v[52:53], v48, s[20:23], s48 offen
    buffer_store_dwordx2 v[54:55], v48, s[20:23], s49 offen
    s_andn2_b64 exec, -1, s[66:67]
    s_cbranch_scc0 k1_s_4
    buffer_store_dword v52, v50, s[20:23], s48 offen
    buffer_store_dword v53, v50, s[20:23], s48 offen offset:128
    buffer_store_dword v54, v50, s[20:23], s49 offen
    buffer_store_dword v55, v50, s[20:23], s49 offen offset:128
k1_s_4:
    s_mov_b64 exec, -1
    s_add_u32 s56, s50, 8
    s_mul_i32 s57, s56, 205
    s_lshr_b32 s57, s57, 10
    s_mul_i32 s58, s57, 5
    s_sub_u32 s62, s56, s58
    s_mul_i32 s57, s57, s46
    s_lshr_b32 s58, s62, 1
    s_lshl_b32 s58, s58, 9
    s_and_b32 s59, s62, 1
    s_lshl_b32 s59, s59, 3
    s_add_u32 s60, s57, s58
    s_add_u32 s60, s60, s59
    s_add_u32 s61, s57, 1024
    s_add_u32 s56, s50, 9
    s_mul_i32 s57, s56, 205
    s_lshr_b32 s57, s57, 10
    s_mul_i32 s58, s57, 5
    s_sub_u32 s65, s56, s58
    s_mul_i32 s57, s57, s46
    s_lshr_b32 s58, s65, 1
    s_lshl_b32 s58, s58, 9
    s_and_b32 s59, s65, 1
    s_lshl_b32 s59, s59, 3
    s_add_u32 s63, s57, s58
    s_add_u32 s63, s63, s59
    s_add_u32 s64, s57, 1024
    s_mov_b64 s[66:67], -1
    s_cmp_eq_u32 s62, 4
    s_cselect_b64 s[66:67], s[52:53], s[66:67]
    s_cmp_eq_u32 s65, 4
    s_cselect_b64 s[66:67], s[54:55], s[66:67]
    v_mov_b32 v48, s60
    v_mov_b32 v49, s63
    v_cndmask_b32 v48, v48, v49, s[52:53]
    v_lshl_add_u32 v48, v13, 4, v48
    v_mov_b32 v50, s61
    v_mov_b32 v49, s64
    v_cndmask_b32 v50, v50, v49, s[52:53]
    v_lshl_add_u32 v50, v13, 2, v50
    v_cvt_pk_bf16_f32 v52, v80, v81
    v_cvt_pk_bf16_f32 v53, v82, v83
    v_cvt_pk_bf16_f32 v54, v112, v113
    v_cvt_pk_bf16_f32 v55, v114, v115
    s_mov_b64 exec, s[66:67]
    buffer_store_dwordx2 v[52:53], v48, s[20:23], s48 offen
    buffer_store_dwordx2 v[54:55], v48, s[20:23], s49 offen
    s_andn2_b64 exec, -1, s[66:67]
    s_cbranch_scc0 k1_s_5
    buffer_store_dword v52, v50, s[20:23], s48 offen
    buffer_store_dword v53, v50, s[20:23], s48 offen offset:128
    buffer_store_dword v54, v50, s[20:23], s49 offen
    buffer_store_dword v55, v50, s[20:23], s49 offen offset:128
k1_s_5:
    s_mov_b64 exec, -1
    s_add_u32 s56, s50, 10
    s_mul_i32 s57, s56, 205
    s_lshr_b32 s57, s57, 10
    s_mul_i32 s58, s57, 5
    s_sub_u32 s62, s56, s58
    s_mul_i32 s57, s57, s46
    s_lshr_b32 s58, s62, 1
    s_lshl_b32 s58, s58, 9
    s_and_b32 s59, s62, 1
    s_lshl_b32 s59, s59, 3
    s_add_u32 s60, s57, s58
    s_add_u32 s60, s60, s59
    s_add_u32 s61, s57, 1024
    s_add_u32 s56, s50, 11
    s_mul_i32 s57, s56, 205
    s_lshr_b32 s57, s57, 10
    s_mul_i32 s58, s57, 5
    s_sub_u32 s65, s56, s58
    s_mul_i32 s57, s57, s46
    s_lshr_b32 s58, s65, 1
    s_lshl_b32 s58, s58, 9
    s_and_b32 s59, s65, 1
    s_lshl_b32 s59, s59, 3
    s_add_u32 s63, s57, s58
    s_add_u32 s63, s63, s59
    s_add_u32 s64, s57, 1024
    s_mov_b64 s[66:67], -1
    s_cmp_eq_u32 s62, 4
    s_cselect_b64 s[66:67], s[52:53], s[66:67]
    s_cmp_eq_u32 s65, 4
    s_cselect_b64 s[66:67], s[54:55], s[66:67]
    v_mov_b32 v48, s60
    v_mov_b32 v49, s63
    v_cndmask_b32 v48, v48, v49, s[52:53]
    v_lshl_add_u32 v48, v13, 4, v48
    v_mov_b32 v50, s61
    v_mov_b32 v49, s64
    v_cndmask_b32 v50, v50, v49, s[52:53]
    v_lshl_add_u32 v50, v13, 2, v50
    v_cvt_pk_bf16_f32 v52, v84, v85
    v_cvt_pk_bf16_f32 v53, v86, v87
    v_cvt_pk_bf16_f32 v54, v116, v117
    v_cvt_pk_bf16_f32 v55, v118, v119
    s_mov_b64 exec, s[66:67]
    buffer_store_dwordx2 v[52:53], v48, s[20:23], s48 offen
    buffer_store_dwordx2 v[54:55], v48, s[20:23], s49 offen
    s_andn2_b64 exec, -1, s[66:67]
    s_cbranch_scc0 k1_s_6
    buffer_store_dword v52, v50, s[20:23], s48 offen
    buffer_store_dword v53, v50, s[20:23], s48 offen offset:128
    buffer_store_dword v54, v50, s[20:23], s49 offen
    buffer_store_dword v55, v50, s[20:23], s49 offen offset:128
k1_s_6:
    s_mov_b64 exec, -1
    s_add_u32 s56, s50, 12
    s_mul_i32 s57, s56, 205
    s_lshr_b32 s57, s57, 10
    s_mul_i32 s58, s57, 5
    s_sub_u32 s62, s56, s58
    s_mul_i32 s57, s57, s46
    s_lshr_b32 s58, s62, 1
    s_lshl_b32 s58, s58, 9
    s_and_b32 s59, s62, 1
    s_lshl_b32 s59, s59, 3
    s_add_u32 s60, s57, s58
    s_add_u32 s60, s60, s59
    s_add_u32 s61, s57, 1024
    s_add_u32 s56, s50, 13
    s_mul_i32 s57, s56, 205
    s_lshr_b32 s57, s57, 10
    s_mul_i32 s58, s57, 5
    s_sub_u32 s65, s56, s58
    s_mul_i32 s57, s57, s46
    s_lshr_b32 s58, s65, 1
    s_lshl_b32 s58, s58, 9
    s_and_b32 s59, s65, 1
    s_lshl_b32 s59, s59, 3
    s_add_u32 s63, s57, s58
    s_add_u32 s63, s63, s59
    s_add_u32 s64, s57, 1024
    s_mov_b64 s[66:67], -1
    s_cmp_eq_u32 s62, 4
    s_cselect_b64 s[66:67], s[52:53], s[66:67]
    s_cmp_eq_u32 s65, 4
    s_cselect_b64 s[66:67], s[54:55], s[66:67]
    v_mov_b32 v48, s60
    v_mov_b32 v49, s63
    v_cndmask_b32 v48, v48, v49, s[52:53]
    v_lshl_add_u32 v48, v13, 4, v48
    v_mov_b32 v50, s61
    v_mov_b32 v49, s64
    v_cndmask_b32 v50, v50, v49, s[52:53]
    v_lshl_add_u32 v50, v13, 2, v50
    v_cvt_pk_bf16_f32 v52, v88, v89
    v_cvt_pk_bf16_f32 v53, v90, v91
    v_cvt_pk_bf16_f32 v54, v120, v121
    v_cvt_pk_bf16_f32 v55, v122, v123
    s_mov_b64 exec, s[66:67]
    buffer_store_dwordx2 v[52:53], v48, s[20:23], s48 offen
    buffer_store_dwordx2 v[54:55], v48, s[20:23], s49 offen
    s_andn2_b64 exec, -1, s[66:67]
    s_cbranch_scc0 k1_s_7
    buffer_store_dword v52, v50, s[20:23], s48 offen
    buffer_store_dword v53, v50, s[20:23], s48 offen offset:128
    buffer_store_dword v54, v50, s[20:23], s49 offen
    buffer_store_dword v55, v50, s[20:23], s49 offen offset:128
k1_s_7:
    s_mov_b64 exec, -1
    s_add_u32 s56, s50, 14
    s_mul_i32 s57, s56, 205
    s_lshr_b32 s57, s57, 10
    s_mul_i32 s58, s57, 5
    s_sub_u32 s62, s56, s58
    s_mul_i32 s57, s57, s46
    s_lshr_b32 s58, s62, 1
    s_lshl_b32 s58, s58, 9
    s_and_b32 s59, s62, 1
    s_lshl_b32 s59, s59, 3
    s_add_u32 s60, s57, s58
    s_add_u32 s60, s60, s59
    s_add_u32 s61, s57, 1024
    s_add_u32 s56, s50, 15
    s_mul_i32 s57, s56, 205
    s_lshr_b32 s57, s57, 10
    s_mul_i32 s58, s57, 5
    s_sub_u32 s65, s56, s58
    s_mul_i32 s57, s57, s46
    s_lshr_b32 s58, s65, 1
    s_lshl_b32 s58, s58, 9
    s_and_b32 s59, s65, 1
    s_lshl_b32 s59, s59, 3
    s_add_u32 s63, s57, s58
    s_add_u32 s63, s63, s59
    s_add_u32 s64, s57, 1024
    s_mov_b64 s[66:67], -1
    s_cmp_eq_u32 s62, 4
    s_cselect_b64 s[66:67], s[52:53], s[66:67]
    s_cmp_eq_u32 s65, 4
    s_cselect_b64 s[66:67], s[54:55], s[66:67]
    v_mov_b32 v48, s60
    v_mov_b32 v49, s63
    v_cndmask_b32 v48, v48, v49, s[52:53]
    v_lshl_add_u32 v48, v13, 4, v48
    v_mov_b32 v50, s61
    v_mov_b32 v49, s64
    v_cndmask_b32 v50, v50, v49, s[52:53]
    v_lshl_add_u32 v50, v13, 2, v50
    v_cvt_pk_bf16_f32 v52, v92, v93
    v_cvt_pk_bf16_f32 v53, v94, v95
    v_cvt_pk_bf16_f32 v54, v124, v125
    v_cvt_pk_bf16_f32 v55, v126, v127
    s_mov_b64 exec, s[66:67]
    buffer_store_dwordx2 v[52:53], v48, s[20:23], s48 offen
    buffer_store_dwordx2 v[54:55], v48, s[20:23], s49 offen
    s_andn2_b64 exec, -1, s[66:67]
    s_cbranch_scc0 k1_s_8
    buffer_store_dword v52, v50, s[20:23], s48 offen
    buffer_store_dword v53, v50, s[20:23], s48 offen offset:128
    buffer_store_dword v54, v50, s[20:23], s49 offen
    buffer_store_dword v55, v50, s[20:23], s49 offen offset:128
k1_s_8:
    s_mov_b64 exec, -1
    s_branch k1_exit
k1_vpath:
    v_mov_b32 v64, 0
    v_mov_b32 v65, 0
    v_mov_b32 v66, 0
    v_mov_b32 v67, 0
    v_mov_b32 v68, 0
    v_mov_b32 v69, 0
    v_mov_b32 v70, 0
    v_mov_b32 v71, 0
    v_mov_b32 v72, 0
    v_mov_b32 v73, 0
    v_mov_b32 v74, 0
    v_mov_b32 v75, 0
    v_mov_b32 v76, 0
    v_mov_b32 v77, 0
    v_mov_b32 v78, 0
    v_mov_b32 v79, 0
    v_mov_b32 v80, 0
    v_mov_b32 v81, 0
    v_mov_b32 v82, 0
    v_mov_b32 v83, 0
    v_mov_b32 v84, 0
    v_mov_b32 v85, 0
    v_mov_b32 v86, 0
    v_mov_b32 v87, 0
    v_mov_b32 v88, 0
    v_mov_b32 v89, 0
    v_mov_b32 v90, 0
    v_mov_b32 v91, 0
    v_mov_b32 v92, 0
    v_mov_b32 v93, 0
    v_mov_b32 v94, 0
    v_mov_b32 v95, 0
    v_mov_b32 v96, 0
    v_mov_b32 v97, 0
    v_mov_b32 v98, 0
    v_mov_b32 v99, 0
    v_mov_b32 v100, 0
    v_mov_b32 v101, 0
    v_mov_b32 v102, 0
    v_mov_b32 v103, 0
    v_mov_b32 v104, 0
    v_mov_b32 v105, 0
    v_mov_b32 v106, 0
    v_mov_b32 v107, 0
    v_mov_b32 v108, 0
    v_mov_b32 v109, 0
    v_mov_b32 v110, 0
    v_mov_b32 v111, 0
    v_mov_b32 v112, 0
    v_mov_b32 v113, 0
    v_mov_b32 v114, 0
    v_mov_b32 v115, 0
    v_mov_b32 v116, 0
    v_mov_b32 v117, 0
    v_mov_b32 v118, 0
    v_mov_b32 v119, 0
    v_mov_b32 v120, 0
    v_mov_b32 v121, 0
    v_mov_b32 v122, 0
    v_mov_b32 v123, 0
    v_mov_b32 v124, 0
    v_mov_b32 v125, 0
    v_mov_b32 v126, 0
    v_mov_b32 v127, 0
    s_add_u32 m0, s46, 0
    s_nop 0
    buffer_load_dwordx4 v2, s[12:15], s40 offen lds
    s_add_u32 m0, s46, 1024
    s_nop 0
    buffer_load_dwordx4 v2, s[12:15], s41 offen lds
    s_add_u32 m0, s46, 8192
    s_nop 0
    buffer_load_dwordx4 v3, s[16:19], s42 offen lds
    s_add_u32 m0, s46, 9216
    s_nop 0
    buffer_load_dwordx4 v3, s[16:19], s43 offen lds
    s_add_u32 s40, s40, 64
    s_add_u32 s42, s42, 122880
    s_add_u32 s41, s41, 64
    s_add_u32 s43, s43, 122880
    s_add_u32 m0, s46, 16384
    s_nop 0
    buffer_load_dwordx4 v2, s[12:15], s40 offen lds
    s_add_u32 m0, s46, 17408
    s_nop 0
    buffer_load_dwordx4 v2, s[12:15], s41 offen lds
    s_add_u32 m0, s46, 24576
    s_nop 0
    buffer_load_dwordx4 v3, s[16:19], s42 offen lds
    s_add_u32 m0, s46, 25600
    s_nop 0
    buffer_load_dwordx4 v3, s[16:19], s43 offen lds
    s_add_u32 s40, s40, 64
    s_add_u32 s42, s42, 122880
    s_add_u32 s41, s41, 64
    s_add_u32 s43, s43, 122880
    s_add_u32 m0, s46, 32768
    s_nop 0
    buffer_load_dwordx4 v2, s[12:15], s40 offen lds
    s_add_u32 m0, s46, 33792
    s_nop 0
    buffer_load_dwordx4 v2, s[12:15], s41 offen lds
    s_add_u32 m0, s46, 40960
    s_nop 0
    buffer_load_dwordx4 v3, s[16:19], s42 offen lds
    s_add_u32 m0, s46, 41984
    s_nop 0
    buffer_load_dwordx4 v3, s[16:19], s43 offen lds
    s_add_u32 s40, s40, 64
    s_add_u32 s42, s42, 122880
    s_add_u32 s41, s41, 64
    s_add_u32 s43, s43, 122880
    s_waitcnt vmcnt(4)
    s_barrier
    ds_read_b128 v[128:131], v8 offset:0
    ds_read_b128 v[132:135], v8 offset:2048
    ds_read_b64_tr_b16 v[136:137], v6 offset:0
    ds_read_b64_tr_b16 v[138:139], v6 offset:1024
    ds_read_b64_tr_b16 v[140:141], v7 offset:0
    ds_read_b64_tr_b16 v[142:143], v7 offset:1024
    ds_read_b128 v[144:147], v9 offset:0
    ds_read_b128 v[148:151], v9 offset:2048
    ds_read_b64_tr_b16 v[152:153], v6 offset:4096
    ds_read_b64_tr_b16 v[154:155], v6 offset:5120
    ds_read_b64_tr_b16 v[156:157], v7 offset:4096
    ds_read_b64_tr_b16 v[158:159], v7 offset:5120
    s_mov_b32 s45, 0
k1_loop_v:
    s_add_u32 m0, s46, 49152
    s_nop 0
    buffer_load_dwordx4 v2, s[12:15], s40 offen lds
    s_add_u32 m0, s46, 50176
    s_nop 0
    buffer_load_dwordx4 v2, s[12:15], s41 offen lds
    s_add_u32 m0, s46, 57344
    s_nop 0
    buffer_load_dwordx4 v3, s[16:19], s42 offen lds
    s_add_u32 m0, s46, 58368
    s_nop 0
    buffer_load_dwordx4 v3, s[16:19], s43 offen lds
    s_add_u32 s40, s40, 64
    s_add_u32 s42, s42, 122880
    s_add_u32 s41, s41, 64
    s_add_u32 s43, s43, 122880
    s_waitcnt lgkmcnt(0)
    ds_read_b128 v[160:163], v8 offset:16384
    ds_read_b128 v[164:167], v8 offset:18432
    ds_read_b64_tr_b16 v[168:169], v6 offset:16384
    ds_read_b64_tr_b16 v[170:171], v6 offset:17408
    ds_read_b64_tr_b16 v[172:173], v7 offset:16384
    ds_read_b64_tr_b16 v[174:175], v7 offset:17408
    ds_read_b128 v[176:179], v9 offset:16384
    ds_read_b128 v[180:183], v9 offset:18432
    ds_read_b64_tr_b16 v[184:185], v6 offset:20480
    ds_read_b64_tr_b16 v[186:187], v6 offset:21504
    ds_read_b64_tr_b16 v[188:189], v7 offset:20480
    ds_read_b64_tr_b16 v[190:191], v7 offset:21504
    v_mfma_f32_32x32x16_bf16 v[64:79], v[128:131], v[136:139], v[64:79]
    v_mfma_f32_32x32x16_bf16 v[80:95], v[128:131], v[140:143], v[80:95]
    v_mfma_f32_32x32x16_bf16 v[96:111], v[132:135], v[136:139], v[96:111]
    v_mfma_f32_32x32x16_bf16 v[112:127], v[132:135], v[140:143], v[112:127]
    v_mfma_f32_32x32x16_bf16 v[64:79], v[144:147], v[152:155], v[64:79]
    v_mfma_f32_32x32x16_bf16 v[80:95], v[144:147], v[156:159], v[80:95]
    v_mfma_f32_32x32x16_bf16 v[96:111], v[148:151], v[152:155], v[96:111]
    v_mfma_f32_32x32x16_bf16 v[112:127], v[148:151], v[156:159], v[112:127]
    s_waitcnt vmcnt(4)
    s_barrier
    s_add_u32 m0, s46, 0
    s_nop 0
    buffer_load_dwordx4 v2, s[12:15], s40 offen lds
    s_add_u32 m0, s46, 1024
    s_nop 0
    buffer_load_dwordx4 v2, s[12:15], s41 offen lds
    s_add_u32 m0, s46, 8192
    s_nop 0
    buffer_load_dwordx4 v3, s[16:19], s42 offen lds
    s_add_u32 m0, s46, 9216
    s_nop 0
    buffer_load_dwordx4 v3, s[16:19], s43 offen lds
    s_add_u32 s40, s40, 64
    s_add_u32 s42, s42, 122880
    s_add_u32 s41, s41, 64
    s_add_u32 s43, s43, 122880
    s_waitcnt lgkmcnt(0)
    ds_read_b128 v[128:131], v8 offset:32768
    ds_read_b128 v[132:135], v8 offset:34816
    ds_read_b64_tr_b16 v[136:137], v6 offset:32768
    ds_read_b64_tr_b16 v[138:139], v6 offset:33792
    ds_read_b64_tr_b16 v[140:141], v7 offset:32768
    ds_read_b64_tr_b16 v[142:143], v7 offset:33792
    ds_read_b128 v[144:147], v9 offset:32768
    ds_read_b128 v[148:151], v9 offset:34816
    ds_read_b64_tr_b16 v[152:153], v6 offset:36864
    ds_read_b64_tr_b16 v[154:155], v6 offset:37888
    ds_read_b64_tr_b16 v[156:157], v7 offset:36864
    ds_read_b64_tr_b16 v[158:159], v7 offset:37888
    v_mfma_f32_32x32x16_bf16 v[64:79], v[160:163], v[168:171], v[64:79]
    v_mfma_f32_32x32x16_bf16 v[80:95], v[160:163], v[172:175], v[80:95]
    v_mfma_f32_32x32x16_bf16 v[96:111], v[164:167], v[168:171], v[96:111]
    v_mfma_f32_32x32x16_bf16 v[112:127], v[164:167], v[172:175], v[112:127]
    v_mfma_f32_32x32x16_bf16 v[64:79], v[176:179], v[184:187], v[64:79]
    v_mfma_f32_32x32x16_bf16 v[80:95], v[176:179], v[188:191], v[80:95]
    v_mfma_f32_32x32x16_bf16 v[96:111], v[180:183], v[184:187], v[96:111]
    v_mfma_f32_32x32x16_bf16 v[112:127], v[180:183], v[188:191], v[112:127]
    s_waitcnt vmcnt(4)
    s_barrier
    s_add_u32 m0, s46, 16384
    s_nop 0
    buffer_load_dwordx4 v2, s[12:15], s40 offen lds
    s_add_u32 m0, s46, 17408
    s_nop 0
    buffer_load_dwordx4 v2, s[12:15], s41 offen lds
    s_add_u32 m0, s46, 24576
    s_nop 0
    buffer_load_dwordx4 v3, s[16:19], s42 offen lds
    s_add_u32 m0, s46, 25600
    s_nop 0
    buffer_load_dwordx4 v3, s[16:19], s43 offen lds
    s_add_u32 s40, s40, 64
    s_add_u32 s42, s42, 122880
    s_add_u32 s41, s41, 64
    s_add_u32 s43, s43, 122880
    s_waitcnt lgkmcnt(0)
    ds_read_b128 v[160:163], v8 offset:49152
    ds_read_b128 v[164:167], v8 offset:51200
    ds_read_b64_tr_b16 v[168:169], v6 offset:49152
    ds_read_b64_tr_b16 v[170:171], v6 offset:50176
    ds_read_b64_tr_b16 v[172:173], v7 offset:49152
    ds_read_b64_tr_b16 v[174:175], v7 offset:50176
    ds_read_b128 v[176:179], v9 offset:49152
    ds_read_b128 v[180:183], v9 offset:51200
    ds_read_b64_tr_b16 v[184:185], v6 offset:53248
    ds_read_b64_tr_b16 v[186:187], v6 offset:54272
    ds_read_b64_tr_b16 v[188:189], v7 offset:53248
    ds_read_b64_tr_b16 v[190:191], v7 offset:54272
    v_mfma_f32_32x32x16_bf16 v[64:79], v[128:131], v[136:139], v[64:79]
    v_mfma_f32_32x32x16_bf16 v[80:95], v[128:131], v[140:143], v[80:95]
    v_mfma_f32_32x32x16_bf16 v[96:111], v[132:135], v[136:139], v[96:111]
    v_mfma_f32_32x32x16_bf16 v[112:127], v[132:135], v[140:143], v[112:127]
    v_mfma_f32_32x32x16_bf16 v[64:79], v[144:147], v[152:155], v[64:79]
    v_mfma_f32_32x32x16_bf16 v[80:95], v[144:147], v[156:159], v[80:95]
    v_mfma_f32_32x32x16_bf16 v[96:111], v[148:151], v[152:155], v[96:111]
    v_mfma_f32_32x32x16_bf16 v[112:127], v[148:151], v[156:159], v[112:127]
    s_waitcnt vmcnt(4)
    s_barrier
    s_add_u32 m0, s46, 32768
    s_nop 0
    buffer_load_dwordx4 v2, s[12:15], s40 offen lds
    s_add_u32 m0, s46, 33792
    s_nop 0
    buffer_load_dwordx4 v2, s[12:15], s41 offen lds
    s_add_u32 m0, s46, 40960
    s_nop 0
    buffer_load_dwordx4 v3, s[16:19], s42 offen lds
    s_add_u32 m0, s46, 41984
    s_nop 0
    buffer_load_dwordx4 v3, s[16:19], s43 offen lds
    s_add_u32 s40, s40, 64
    s_add_u32 s42, s42, 122880
    s_add_u32 s41, s41, 64
    s_add_u32 s43, s43, 122880
    s_waitcnt lgkmcnt(0)
    ds_read_b128 v[128:131], v8 offset:0
    ds_read_b128 v[132:135], v8 offset:2048
    ds_read_b64_tr_b16 v[136:137], v6 offset:0
    ds_read_b64_tr_b16 v[138:139], v6 offset:1024
    ds_read_b64_tr_b16 v[140:141], v7 offset:0
    ds_read_b64_tr_b16 v[142:143], v7 offset:1024
    ds_read_b128 v[144:147], v9 offset:0
    ds_read_b128 v[148:151], v9 offset:2048
    ds_read_b64_tr_b16 v[152:153], v6 offset:4096
    ds_read_b64_tr_b16 v[154:155], v6 offset:5120
    ds_read_b64_tr_b16 v[156:157], v7 offset:4096
    ds_read_b64_tr_b16 v[158:159], v7 offset:5120
    v_mfma_f32_32x32x16_bf16 v[64:79], v[160:163], v[168:171], v[64:79]
    v_mfma_f32_32x32x16_bf16 v[80:95], v[160:163], v[172:175], v[80:95]
    v_mfma_f32_32x32x16_bf16 v[96:111], v[164:167], v[168:171], v[96:111]
    v_mfma_f32_32x32x16_bf16 v[112:127], v[164:167], v[172:175], v[112:127]
    v_mfma_f32_32x32x16_bf16 v[64:79], v[176:179], v[184:187], v[64:79]
    v_mfma_f32_32x32x16_bf16 v[80:95], v[176:179], v[188:191], v[80:95]
    v_mfma_f32_32x32x16_bf16 v[96:111], v[180:183], v[184:187], v[96:111]
    v_mfma_f32_32x32x16_bf16 v[112:127], v[180:183], v[188:191], v[112:127]
    s_waitcnt vmcnt(4)
    s_barrier
    s_add_u32 s45, s45, 1
    s_cmp_lt_u32 s45, 5
    s_nop 7
    s_cbranch_scc1 k1_loop_v
    s_waitcnt vmcnt(0) lgkmcnt(0)
    s_cmp_ge_u32 s26, 3
    s_mov_b32 s48, 0
    s_cselect_b32 s48, 6291456, s48
    s_lshl_b32 s49, s24, 2
    s_lshl_b32 s50, s29, 1
    s_add_u32 s49, s49, s50
    s_mul_i32 s49, s49, 2624
    s_add_u32 s48, s48, s49
    s_add_u32 s49, s48, 2624
    v_mov_b32 v56, 0x3f803f80
    v_mov_b32 v57, 0x3f803f80
    v_mov_b32 v58, 0x3f803f80
    v_mov_b32 v59, 0x3f803f80
    s_lshl_b32 s50, s30, 6
    s_add_u32 s50, s50, s27
    s_add_u32 s50, s50, 0
    v_add_u32 v48, s50, v13
    v_mul_u32_u24 v49, 3277, v48
    v_lshrrev_b32 v49, 16, v49
    v_mul_u32_u24 v50, 20, v49
    v_sub_u32 v50, v48, v50
    s_mov_b32 s51, 167936
    v_mul_lo_u32 v49, v49, s51
    v_lshl_add_u32 v49, v50, 4, v49
    v_mul_u32_u24 v51, 336, v14
    v_add_u32 v49, v49, v51
    v_add_u32 v49, 1280, v49
    v_cmp_eq_u32 s[56:57], 0, v50
    v_cvt_pk_bf16_f32 v52, v64, v65
    v_cvt_pk_bf16_f32 v53, v66, v67
    v_cvt_pk_bf16_f32 v54, v68, v69
    v_cvt_pk_bf16_f32 v55, v70, v71
    buffer_store_dwordx4 v[52:55], v49, s[20:23], s48 offen offset:0
    s_nop 1
    v_cvt_pk_bf16_f32 v52, v72, v73
    v_cvt_pk_bf16_f32 v53, v74, v75
    v_cvt_pk_bf16_f32 v54, v76, v77
    v_cvt_pk_bf16_f32 v55, v78, v79
    buffer_store_dwordx4 v[52:55], v49, s[20:23], s48 offen offset:672
    s_nop 1
    v_cvt_pk_bf16_f32 v52, v96, v97
    v_cvt_pk_bf16_f32 v53, v98, v99
    v_cvt_pk_bf16_f32 v54, v100, v101
    v_cvt_pk_bf16_f32 v55, v102, v103
    buffer_store_dwordx4 v[52:55], v49, s[20:23], s49 offen offset:0
    s_nop 1
    v_cvt_pk_bf16_f32 v52, v104, v105
    v_cvt_pk_bf16_f32 v53, v106, v107
    v_cvt_pk_bf16_f32 v54, v108, v109
    v_cvt_pk_bf16_f32 v55, v110, v111
    buffer_store_dwordx4 v[52:55], v49, s[20:23], s49 offen offset:672
    s_and_b64 exec, s[56:57], s[56:57]
    s_nop 0
    s_cbranch_scc0 k1_v_9
    buffer_store_dwordx4 v[56:59], v49, s[20:23], s48 offen offset:320
    buffer_store_dwordx4 v[56:59], v49, s[20:23], s48 offen offset:992
    buffer_store_dwordx4 v[56:59], v49, s[20:23], s49 offen offset:320
    buffer_store_dwordx4 v[56:59], v49, s[20:23], s49 offen offset:992
    s_nop 1
k1_v_9:
    s_mov_b64 exec, -1
    s_lshl_b32 s50, s30, 6
    s_add_u32 s50, s50, s27
    s_add_u32 s50, s50, 32
    v_add_u32 v48, s50, v13
    v_mul_u32_u24 v49, 3277, v48
    v_lshrrev_b32 v49, 16, v49
    v_mul_u32_u24 v50, 20, v49
    v_sub_u32 v50, v48, v50
    s_mov_b32 s51, 167936
    v_mul_lo_u32 v49, v49, s51
    v_lshl_add_u32 v49, v50, 4, v49
    v_mul_u32_u24 v51, 336, v14
    v_add_u32 v49, v49, v51
    v_add_u32 v49, 1280, v49
    v_cmp_eq_u32 s[56:57], 0, v50
    v_cvt_pk_bf16_f32 v52, v80, v81
    v_cvt_pk_bf16_f32 v53, v82, v83
    v_cvt_pk_bf16_f32 v54, v84, v85
    v_cvt_pk_bf16_f32 v55, v86, v87
    buffer_store_dwordx4 v[52:55], v49, s[20:23], s48 offen offset:0
    s_nop 1
    v_cvt_pk_bf16_f32 v52, v88, v89
    v_cvt_pk_bf16_f32 v53, v90, v91
    v_cvt_pk_bf16_f32 v54, v92, v93
    v_cvt_pk_bf16_f32 v55, v94, v95
    buffer_store_dwordx4 v[52:55], v49, s[20:23], s48 offen offset:672
    s_nop 1
    v_cvt_pk_bf16_f32 v52, v112, v113
    v_cvt_pk_bf16_f32 v53, v114, v115
    v_cvt_pk_bf16_f32 v54, v116, v117
    v_cvt_pk_bf16_f32 v55, v118, v119
    buffer_store_dwordx4 v[52:55], v49, s[20:23], s49 offen offset:0
    s_nop 1
    v_cvt_pk_bf16_f32 v52, v120, v121
    v_cvt_pk_bf16_f32 v53, v122, v123
    v_cvt_pk_bf16_f32 v54, v124, v125
    v_cvt_pk_bf16_f32 v55, v126, v127
    buffer_store_dwordx4 v[52:55], v49, s[20:23], s49 offen offset:672
    s_and_b64 exec, s[56:57], s[56:57]
    s_nop 0
    s_cbranch_scc0 k1_v_10
    buffer_store_dwordx4 v[56:59], v49, s[20:23], s48 offen offset:320
    buffer_store_dwordx4 v[56:59], v49, s[20:23], s48 offen offset:992
    buffer_store_dwordx4 v[56:59], v49, s[20:23], s49 offen offset:320
    buffer_store_dwordx4 v[56:59], v49, s[20:23], s49 offen offset:992
    s_nop 1
k1_v_10:
    s_mov_b64 exec, -1
    s_branch k1_exit
k1_gate:
    s_mov_b32 s16, s36
    s_and_b32 s17, s37, 0xffff
    s_mov_b32 s18, 0x500
    s_mov_b32 s19, 0x00020000
    s_sub_u32 s24, s2, 480
    v_lshrrev_b32 v1, 2, v0
    s_lshl_b32 s25, s24, 6
    v_add_u32 v1, s25, v1
    v_and_b32 v2, 3, v0
    v_mul_u32_u24 v2, 320, v2
    s_mov_b32 s26, 1280
    v_mul_lo_u32 v3, v1, s26
    v_add_u32 v3, v3, v2
    buffer_load_dwordx4 v[16:19], v3, s[12:15], 0 offen offset:0
    buffer_load_dwordx4 v[20:23], v3, s[12:15], 0 offen offset:16
    buffer_load_dwordx4 v[24:27], v3, s[12:15], 0 offen offset:32
    buffer_load_dwordx4 v[28:31], v3, s[12:15], 0 offen offset:48
    buffer_load_dwordx4 v[32:35], v3, s[12:15], 0 offen offset:64
    buffer_load_dwordx4 v[36:39], v3, s[12:15], 0 offen offset:80
    buffer_load_dwordx4 v[40:43], v3, s[12:15], 0 offen offset:96
    buffer_load_dwordx4 v[44:47], v3, s[12:15], 0 offen offset:112
    buffer_load_dwordx4 v[48:51], v3, s[12:15], 0 offen offset:128
    buffer_load_dwordx4 v[52:55], v3, s[12:15], 0 offen offset:144
    buffer_load_dwordx4 v[56:59], v3, s[12:15], 0 offen offset:160
    buffer_load_dwordx4 v[60:63], v3, s[12:15], 0 offen offset:176
    buffer_load_dwordx4 v[64:67], v3, s[12:15], 0 offen offset:192
    buffer_load_dwordx4 v[68:71], v3, s[12:15], 0 offen offset:208
    buffer_load_dwordx4 v[72:75], v3, s[12:15], 0 offen offset:224
    buffer_load_dwordx4 v[76:79], v3, s[12:15], 0 offen offset:240
    buffer_load_dwordx4 v[80:83], v3, s[12:15], 0 offen offset:256
    buffer_load_dwordx4 v[84:87], v3, s[12:15], 0 offen offset:272
    buffer_load_dwordx4 v[88:91], v3, s[12:15], 0 offen offset:288
    buffer_load_dwordx4 v[92:95], v3, s[12:15], 0 offen offset:304
    buffer_load_dwordx4 v[96:99], v2, s[16:19], 0 offen offset:0
    buffer_load_dwordx4 v[100:103], v2, s[16:19], 0 offen offset:16
    buffer_load_dwordx4 v[104:107], v2, s[16:19], 0 offen offset:32
    buffer_load_dwordx4 v[108:111], v2, s[16:19], 0 offen offset:48
    buffer_load_dwordx4 v[112:115], v2, s[16:19], 0 offen offset:64
    buffer_load_dwordx4 v[116:119], v2, s[16:19], 0 offen offset:80
    buffer_load_dwordx4 v[120:123], v2, s[16:19], 0 offen offset:96
    buffer_load_dwordx4 v[124:127], v2, s[16:19], 0 offen offset:112
    buffer_load_dwordx4 v[128:131], v2, s[16:19], 0 offen offset:128
    buffer_load_dwordx4 v[132:135], v2, s[16:19], 0 offen offset:144
    buffer_load_dwordx4 v[136:139], v2, s[16:19], 0 offen offset:160
    buffer_load_dwordx4 v[140:143], v2, s[16:19], 0 offen offset:176
    buffer_load_dwordx4 v[144:147], v2, s[16:19], 0 offen offset:192
    buffer_load_dwordx4 v[148:151], v2, s[16:19], 0 offen offset:208
    buffer_load_dwordx4 v[152:155], v2, s[16:19], 0 offen offset:224
    buffer_load_dwordx4 v[156:159], v2, s[16:19], 0 offen offset:240
    buffer_load_dwordx4 v[160:163], v2, s[16:19], 0 offen offset:256
    buffer_load_dwordx4 v[164:167], v2, s[16:19], 0 offen offset:272
    buffer_load_dwordx4 v[168:171], v2, s[16:19], 0 offen offset:288
    buffer_load_dwordx4 v[172:175], v2, s[16:19], 0 offen offset:304
    v_mov_b32 v4, 0
    v_mov_b32 v5, 0
    s_waitcnt vmcnt(0)
    v_lshlrev_b32 v6, 16, v16
    v_lshlrev_b32 v7, 16, v96
    v_fmac_f32 v4, v6, v7
    v_and_b32 v8, 0xffff0000, v16
    v_and_b32 v9, 0xffff0000, v96
    v_fmac_f32 v5, v8, v9
    v_lshlrev_b32 v6, 16, v17
    v_lshlrev_b32 v7, 16, v97
    v_fmac_f32 v4, v6, v7
    v_and_b32 v8, 0xffff0000, v17
    v_and_b32 v9, 0xffff0000, v97
    v_fmac_f32 v5, v8, v9
    v_lshlrev_b32 v6, 16, v18
    v_lshlrev_b32 v7, 16, v98
    v_fmac_f32 v4, v6, v7
    v_and_b32 v8, 0xffff0000, v18
    v_and_b32 v9, 0xffff0000, v98
    v_fmac_f32 v5, v8, v9
    v_lshlrev_b32 v6, 16, v19
    v_lshlrev_b32 v7, 16, v99
    v_fmac_f32 v4, v6, v7
    v_and_b32 v8, 0xffff0000, v19
    v_and_b32 v9, 0xffff0000, v99
    v_fmac_f32 v5, v8, v9
    v_lshlrev_b32 v6, 16, v20
    v_lshlrev_b32 v7, 16, v100
    v_fmac_f32 v4, v6, v7
    v_and_b32 v8, 0xffff0000, v20
    v_and_b32 v9, 0xffff0000, v100
    v_fmac_f32 v5, v8, v9
    v_lshlrev_b32 v6, 16, v21
    v_lshlrev_b32 v7, 16, v101
    v_fmac_f32 v4, v6, v7
    v_and_b32 v8, 0xffff0000, v21
    v_and_b32 v9, 0xffff0000, v101
    v_fmac_f32 v5, v8, v9
    v_lshlrev_b32 v6, 16, v22
    v_lshlrev_b32 v7, 16, v102
    v_fmac_f32 v4, v6, v7
    v_and_b32 v8, 0xffff0000, v22
    v_and_b32 v9, 0xffff0000, v102
    v_fmac_f32 v5, v8, v9
    v_lshlrev_b32 v6, 16, v23
    v_lshlrev_b32 v7, 16, v103
    v_fmac_f32 v4, v6, v7
    v_and_b32 v8, 0xffff0000, v23
    v_and_b32 v9, 0xffff0000, v103
    v_fmac_f32 v5, v8, v9
    v_lshlrev_b32 v6, 16, v24
    v_lshlrev_b32 v7, 16, v104
    v_fmac_f32 v4, v6, v7
    v_and_b32 v8, 0xffff0000, v24
    v_and_b32 v9, 0xffff0000, v104
    v_fmac_f32 v5, v8, v9
    v_lshlrev_b32 v6, 16, v25
    v_lshlrev_b32 v7, 16, v105
    v_fmac_f32 v4, v6, v7
    v_and_b32 v8, 0xffff0000, v25
    v_and_b32 v9, 0xffff0000, v105
    v_fmac_f32 v5, v8, v9
    v_lshlrev_b32 v6, 16, v26
    v_lshlrev_b32 v7, 16, v106
    v_fmac_f32 v4, v6, v7
    v_and_b32 v8, 0xffff0000, v26
    v_and_b32 v9, 0xffff0000, v106
    v_fmac_f32 v5, v8, v9
    v_lshlrev_b32 v6, 16, v27
    v_lshlrev_b32 v7, 16, v107
    v_fmac_f32 v4, v6, v7
    v_and_b32 v8, 0xffff0000, v27
    v_and_b32 v9, 0xffff0000, v107
    v_fmac_f32 v5, v8, v9
    v_lshlrev_b32 v6, 16, v28
    v_lshlrev_b32 v7, 16, v108
    v_fmac_f32 v4, v6, v7
    v_and_b32 v8, 0xffff0000, v28
    v_and_b32 v9, 0xffff0000, v108
    v_fmac_f32 v5, v8, v9
    v_lshlrev_b32 v6, 16, v29
    v_lshlrev_b32 v7, 16, v109
    v_fmac_f32 v4, v6, v7
    v_and_b32 v8, 0xffff0000, v29
    v_and_b32 v9, 0xffff0000, v109
    v_fmac_f32 v5, v8, v9
    v_lshlrev_b32 v6, 16, v30
    v_lshlrev_b32 v7, 16, v110
    v_fmac_f32 v4, v6, v7
    v_and_b32 v8, 0xffff0000, v30
    v_and_b32 v9, 0xffff0000, v110
    v_fmac_f32 v5, v8, v9
    v_lshlrev_b32 v6, 16, v31
    v_lshlrev_b32 v7, 16, v111
    v_fmac_f32 v4, v6, v7
    v_and_b32 v8, 0xffff0000, v31
    v_and_b32 v9, 0xffff0000, v111
    v_fmac_f32 v5, v8, v9
    v_lshlrev_b32 v6, 16, v32
    v_lshlrev_b32 v7, 16, v112
    v_fmac_f32 v4, v6, v7
    v_and_b32 v8, 0xffff0000, v32
    v_and_b32 v9, 0xffff0000, v112
    v_fmac_f32 v5, v8, v9
    v_lshlrev_b32 v6, 16, v33
    v_lshlrev_b32 v7, 16, v113
    v_fmac_f32 v4, v6, v7
    v_and_b32 v8, 0xffff0000, v33
    v_and_b32 v9, 0xffff0000, v113
    v_fmac_f32 v5, v8, v9
    v_lshlrev_b32 v6, 16, v34
    v_lshlrev_b32 v7, 16, v114
    v_fmac_f32 v4, v6, v7
    v_and_b32 v8, 0xffff0000, v34
    v_and_b32 v9, 0xffff0000, v114
    v_fmac_f32 v5, v8, v9
    v_lshlrev_b32 v6, 16, v35
    v_lshlrev_b32 v7, 16, v115
    v_fmac_f32 v4, v6, v7
    v_and_b32 v8, 0xffff0000, v35
    v_and_b32 v9, 0xffff0000, v115
    v_fmac_f32 v5, v8, v9
    v_lshlrev_b32 v6, 16, v36
    v_lshlrev_b32 v7, 16, v116
    v_fmac_f32 v4, v6, v7
    v_and_b32 v8, 0xffff0000, v36
    v_and_b32 v9, 0xffff0000, v116
    v_fmac_f32 v5, v8, v9
    v_lshlrev_b32 v6, 16, v37
    v_lshlrev_b32 v7, 16, v117
    v_fmac_f32 v4, v6, v7
    v_and_b32 v8, 0xffff0000, v37
    v_and_b32 v9, 0xffff0000, v117
    v_fmac_f32 v5, v8, v9
    v_lshlrev_b32 v6, 16, v38
    v_lshlrev_b32 v7, 16, v118
    v_fmac_f32 v4, v6, v7
    v_and_b32 v8, 0xffff0000, v38
    v_and_b32 v9, 0xffff0000, v118
    v_fmac_f32 v5, v8, v9
    v_lshlrev_b32 v6, 16, v39
    v_lshlrev_b32 v7, 16, v119
    v_fmac_f32 v4, v6, v7
    v_and_b32 v8, 0xffff0000, v39
    v_and_b32 v9, 0xffff0000, v119
    v_fmac_f32 v5, v8, v9
    v_lshlrev_b32 v6, 16, v40
    v_lshlrev_b32 v7, 16, v120
    v_fmac_f32 v4, v6, v7
    v_and_b32 v8, 0xffff0000, v40
    v_and_b32 v9, 0xffff0000, v120
    v_fmac_f32 v5, v8, v9
    v_lshlrev_b32 v6, 16, v41
    v_lshlrev_b32 v7, 16, v121
    v_fmac_f32 v4, v6, v7
    v_and_b32 v8, 0xffff0000, v41
    v_and_b32 v9, 0xffff0000, v121
    v_fmac_f32 v5, v8, v9
    v_lshlrev_b32 v6, 16, v42
    v_lshlrev_b32 v7, 16, v122
    v_fmac_f32 v4, v6, v7
    v_and_b32 v8, 0xffff0000, v42
    v_and_b32 v9, 0xffff0000, v122
    v_fmac_f32 v5, v8, v9
    v_lshlrev_b32 v6, 16, v43
    v_lshlrev_b32 v7, 16, v123
    v_fmac_f32 v4, v6, v7
    v_and_b32 v8, 0xffff0000, v43
    v_and_b32 v9, 0xffff0000, v123
    v_fmac_f32 v5, v8, v9
    v_lshlrev_b32 v6, 16, v44
    v_lshlrev_b32 v7, 16, v124
    v_fmac_f32 v4, v6, v7
    v_and_b32 v8, 0xffff0000, v44
    v_and_b32 v9, 0xffff0000, v124
    v_fmac_f32 v5, v8, v9
    v_lshlrev_b32 v6, 16, v45
    v_lshlrev_b32 v7, 16, v125
    v_fmac_f32 v4, v6, v7
    v_and_b32 v8, 0xffff0000, v45
    v_and_b32 v9, 0xffff0000, v125
    v_fmac_f32 v5, v8, v9
    v_lshlrev_b32 v6, 16, v46
    v_lshlrev_b32 v7, 16, v126
    v_fmac_f32 v4, v6, v7
    v_and_b32 v8, 0xffff0000, v46
    v_and_b32 v9, 0xffff0000, v126
    v_fmac_f32 v5, v8, v9
    v_lshlrev_b32 v6, 16, v47
    v_lshlrev_b32 v7, 16, v127
    v_fmac_f32 v4, v6, v7
    v_and_b32 v8, 0xffff0000, v47
    v_and_b32 v9, 0xffff0000, v127
    v_fmac_f32 v5, v8, v9
    v_lshlrev_b32 v6, 16, v48
    v_lshlrev_b32 v7, 16, v128
    v_fmac_f32 v4, v6, v7
    v_and_b32 v8, 0xffff0000, v48
    v_and_b32 v9, 0xffff0000, v128
    v_fmac_f32 v5, v8, v9
    v_lshlrev_b32 v6, 16, v49
    v_lshlrev_b32 v7, 16, v129
    v_fmac_f32 v4, v6, v7
    v_and_b32 v8, 0xffff0000, v49
    v_and_b32 v9, 0xffff0000, v129
    v_fmac_f32 v5, v8, v9
    v_lshlrev_b32 v6, 16, v50
    v_lshlrev_b32 v7, 16, v130
    v_fmac_f32 v4, v6, v7
    v_and_b32 v8, 0xffff0000, v50
    v_and_b32 v9, 0xffff0000, v130
    v_fmac_f32 v5, v8, v9
    v_lshlrev_b32 v6, 16, v51
    v_lshlrev_b32 v7, 16, v131
    v_fmac_f32 v4, v6, v7
    v_and_b32 v8, 0xffff0000, v51
    v_and_b32 v9, 0xffff0000, v131
    v_fmac_f32 v5, v8, v9
    v_lshlrev_b32 v6, 16, v52
    v_lshlrev_b32 v7, 16, v132
    v_fmac_f32 v4, v6, v7
    v_and_b32 v8, 0xffff0000, v52
    v_and_b32 v9, 0xffff0000, v132
    v_fmac_f32 v5, v8, v9
    v_lshlrev_b32 v6, 16, v53
    v_lshlrev_b32 v7, 16, v133
    v_fmac_f32 v4, v6, v7
    v_and_b32 v8, 0xffff0000, v53
    v_and_b32 v9, 0xffff0000, v133
    v_fmac_f32 v5, v8, v9
    v_lshlrev_b32 v6, 16, v54
    v_lshlrev_b32 v7, 16, v134
    v_fmac_f32 v4, v6, v7
    v_and_b32 v8, 0xffff0000, v54
    v_and_b32 v9, 0xffff0000, v134
    v_fmac_f32 v5, v8, v9
    v_lshlrev_b32 v6, 16, v55
    v_lshlrev_b32 v7, 16, v135
    v_fmac_f32 v4, v6, v7
    v_and_b32 v8, 0xffff0000, v55
    v_and_b32 v9, 0xffff0000, v135
    v_fmac_f32 v5, v8, v9
    v_lshlrev_b32 v6, 16, v56
    v_lshlrev_b32 v7, 16, v136
    v_fmac_f32 v4, v6, v7
    v_and_b32 v8, 0xffff0000, v56
    v_and_b32 v9, 0xffff0000, v136
    v_fmac_f32 v5, v8, v9
    v_lshlrev_b32 v6, 16, v57
    v_lshlrev_b32 v7, 16, v137
    v_fmac_f32 v4, v6, v7
    v_and_b32 v8, 0xffff0000, v57
    v_and_b32 v9, 0xffff0000, v137
    v_fmac_f32 v5, v8, v9
    v_lshlrev_b32 v6, 16, v58
    v_lshlrev_b32 v7, 16, v138
    v_fmac_f32 v4, v6, v7
    v_and_b32 v8, 0xffff0000, v58
    v_and_b32 v9, 0xffff0000, v138
    v_fmac_f32 v5, v8, v9
    v_lshlrev_b32 v6, 16, v59
    v_lshlrev_b32 v7, 16, v139
    v_fmac_f32 v4, v6, v7
    v_and_b32 v8, 0xffff0000, v59
    v_and_b32 v9, 0xffff0000, v139
    v_fmac_f32 v5, v8, v9
    v_lshlrev_b32 v6, 16, v60
    v_lshlrev_b32 v7, 16, v140
    v_fmac_f32 v4, v6, v7
    v_and_b32 v8, 0xffff0000, v60
    v_and_b32 v9, 0xffff0000, v140
    v_fmac_f32 v5, v8, v9
    v_lshlrev_b32 v6, 16, v61
    v_lshlrev_b32 v7, 16, v141
    v_fmac_f32 v4, v6, v7
    v_and_b32 v8, 0xffff0000, v61
    v_and_b32 v9, 0xffff0000, v141
    v_fmac_f32 v5, v8, v9
    v_lshlrev_b32 v6, 16, v62
    v_lshlrev_b32 v7, 16, v142
    v_fmac_f32 v4, v6, v7
    v_and_b32 v8, 0xffff0000, v62
    v_and_b32 v9, 0xffff0000, v142
    v_fmac_f32 v5, v8, v9
    v_lshlrev_b32 v6, 16, v63
    v_lshlrev_b32 v7, 16, v143
    v_fmac_f32 v4, v6, v7
    v_and_b32 v8, 0xffff0000, v63
    v_and_b32 v9, 0xffff0000, v143
    v_fmac_f32 v5, v8, v9
    v_lshlrev_b32 v6, 16, v64
    v_lshlrev_b32 v7, 16, v144
    v_fmac_f32 v4, v6, v7
    v_and_b32 v8, 0xffff0000, v64
    v_and_b32 v9, 0xffff0000, v144
    v_fmac_f32 v5, v8, v9
    v_lshlrev_b32 v6, 16, v65
    v_lshlrev_b32 v7, 16, v145
    v_fmac_f32 v4, v6, v7
    v_and_b32 v8, 0xffff0000, v65
    v_and_b32 v9, 0xffff0000, v145
    v_fmac_f32 v5, v8, v9
    v_lshlrev_b32 v6, 16, v66
    v_lshlrev_b32 v7, 16, v146
    v_fmac_f32 v4, v6, v7
    v_and_b32 v8, 0xffff0000, v66
    v_and_b32 v9, 0xffff0000, v146
    v_fmac_f32 v5, v8, v9
    v_lshlrev_b32 v6, 16, v67
    v_lshlrev_b32 v7, 16, v147
    v_fmac_f32 v4, v6, v7
    v_and_b32 v8, 0xffff0000, v67
    v_and_b32 v9, 0xffff0000, v147
    v_fmac_f32 v5, v8, v9
    v_lshlrev_b32 v6, 16, v68
    v_lshlrev_b32 v7, 16, v148
    v_fmac_f32 v4, v6, v7
    v_and_b32 v8, 0xffff0000, v68
    v_and_b32 v9, 0xffff0000, v148
    v_fmac_f32 v5, v8, v9
    v_lshlrev_b32 v6, 16, v69
    v_lshlrev_b32 v7, 16, v149
    v_fmac_f32 v4, v6, v7
    v_and_b32 v8, 0xffff0000, v69
    v_and_b32 v9, 0xffff0000, v149
    v_fmac_f32 v5, v8, v9
    v_lshlrev_b32 v6, 16, v70
    v_lshlrev_b32 v7, 16, v150
    v_fmac_f32 v4, v6, v7
    v_and_b32 v8, 0xffff0000, v70
    v_and_b32 v9, 0xffff0000, v150
    v_fmac_f32 v5, v8, v9
    v_lshlrev_b32 v6, 16, v71
    v_lshlrev_b32 v7, 16, v151
    v_fmac_f32 v4, v6, v7
    v_and_b32 v8, 0xffff0000, v71
    v_and_b32 v9, 0xffff0000, v151
    v_fmac_f32 v5, v8, v9
    v_lshlrev_b32 v6, 16, v72
    v_lshlrev_b32 v7, 16, v152
    v_fmac_f32 v4, v6, v7
    v_and_b32 v8, 0xffff0000, v72
    v_and_b32 v9, 0xffff0000, v152
    v_fmac_f32 v5, v8, v9
    v_lshlrev_b32 v6, 16, v73
    v_lshlrev_b32 v7, 16, v153
    v_fmac_f32 v4, v6, v7
    v_and_b32 v8, 0xffff0000, v73
    v_and_b32 v9, 0xffff0000, v153
    v_fmac_f32 v5, v8, v9
    v_lshlrev_b32 v6, 16, v74
    v_lshlrev_b32 v7, 16, v154
    v_fmac_f32 v4, v6, v7
    v_and_b32 v8, 0xffff0000, v74
    v_and_b32 v9, 0xffff0000, v154
    v_fmac_f32 v5, v8, v9
    v_lshlrev_b32 v6, 16, v75
    v_lshlrev_b32 v7, 16, v155
    v_fmac_f32 v4, v6, v7
    v_and_b32 v8, 0xffff0000, v75
    v_and_b32 v9, 0xffff0000, v155
    v_fmac_f32 v5, v8, v9
    v_lshlrev_b32 v6, 16, v76
    v_lshlrev_b32 v7, 16, v156
    v_fmac_f32 v4, v6, v7
    v_and_b32 v8, 0xffff0000, v76
    v_and_b32 v9, 0xffff0000, v156
    v_fmac_f32 v5, v8, v9
    v_lshlrev_b32 v6, 16, v77
    v_lshlrev_b32 v7, 16, v157
    v_fmac_f32 v4, v6, v7
    v_and_b32 v8, 0xffff0000, v77
    v_and_b32 v9, 0xffff0000, v157
    v_fmac_f32 v5, v8, v9
    v_lshlrev_b32 v6, 16, v78
    v_lshlrev_b32 v7, 16, v158
    v_fmac_f32 v4, v6, v7
    v_and_b32 v8, 0xffff0000, v78
    v_and_b32 v9, 0xffff0000, v158
    v_fmac_f32 v5, v8, v9
    v_lshlrev_b32 v6, 16, v79
    v_lshlrev_b32 v7, 16, v159
    v_fmac_f32 v4, v6, v7
    v_and_b32 v8, 0xffff0000, v79
    v_and_b32 v9, 0xffff0000, v159
    v_fmac_f32 v5, v8, v9
    v_lshlrev_b32 v6, 16, v80
    v_lshlrev_b32 v7, 16, v160
    v_fmac_f32 v4, v6, v7
    v_and_b32 v8, 0xffff0000, v80
    v_and_b32 v9, 0xffff0000, v160
    v_fmac_f32 v5, v8, v9
    v_lshlrev_b32 v6, 16, v81
    v_lshlrev_b32 v7, 16, v161
    v_fmac_f32 v4, v6, v7
    v_and_b32 v8, 0xffff0000, v81
    v_and_b32 v9, 0xffff0000, v161
    v_fmac_f32 v5, v8, v9
    v_lshlrev_b32 v6, 16, v82
    v_lshlrev_b32 v7, 16, v162
    v_fmac_f32 v4, v6, v7
    v_and_b32 v8, 0xffff0000, v82
    v_and_b32 v9, 0xffff0000, v162
    v_fmac_f32 v5, v8, v9
    v_lshlrev_b32 v6, 16, v83
    v_lshlrev_b32 v7, 16, v163
    v_fmac_f32 v4, v6, v7
    v_and_b32 v8, 0xffff0000, v83
    v_and_b32 v9, 0xffff0000, v163
    v_fmac_f32 v5, v8, v9
    v_lshlrev_b32 v6, 16, v84
    v_lshlrev_b32 v7, 16, v164
    v_fmac_f32 v4, v6, v7
    v_and_b32 v8, 0xffff0000, v84
    v_and_b32 v9, 0xffff0000, v164
    v_fmac_f32 v5, v8, v9
    v_lshlrev_b32 v6, 16, v85
    v_lshlrev_b32 v7, 16, v165
    v_fmac_f32 v4, v6, v7
    v_and_b32 v8, 0xffff0000, v85
    v_and_b32 v9, 0xffff0000, v165
    v_fmac_f32 v5, v8, v9
    v_lshlrev_b32 v6, 16, v86
    v_lshlrev_b32 v7, 16, v166
    v_fmac_f32 v4, v6, v7
    v_and_b32 v8, 0xffff0000, v86
    v_and_b32 v9, 0xffff0000, v166
    v_fmac_f32 v5, v8, v9
    v_lshlrev_b32 v6, 16, v87
    v_lshlrev_b32 v7, 16, v167
    v_fmac_f32 v4, v6, v7
    v_and_b32 v8, 0xffff0000, v87
    v_and_b32 v9, 0xffff0000, v167
    v_fmac_f32 v5, v8, v9
    v_lshlrev_b32 v6, 16, v88
    v_lshlrev_b32 v7, 16, v168
    v_fmac_f32 v4, v6, v7
    v_and_b32 v8, 0xffff0000, v88
    v_and_b32 v9, 0xffff0000, v168
    v_fmac_f32 v5, v8, v9
    v_lshlrev_b32 v6, 16, v89
    v_lshlrev_b32 v7, 16, v169
    v_fmac_f32 v4, v6, v7
    v_and_b32 v8, 0xffff0000, v89
    v_and_b32 v9, 0xffff0000, v169
    v_fmac_f32 v5, v8, v9
    v_lshlrev_b32 v6, 16, v90
    v_lshlrev_b32 v7, 16, v170
    v_fmac_f32 v4, v6, v7
    v_and_b32 v8, 0xffff0000, v90
    v_and_b32 v9, 0xffff0000, v170
    v_fmac_f32 v5, v8, v9
    v_lshlrev_b32 v6, 16, v91
    v_lshlrev_b32 v7, 16, v171
    v_fmac_f32 v4, v6, v7
    v_and_b32 v8, 0xffff0000, v91
    v_and_b32 v9, 0xffff0000, v171
    v_fmac_f32 v5, v8, v9
    v_lshlrev_b32 v6, 16, v92
    v_lshlrev_b32 v7, 16, v172
    v_fmac_f32 v4, v6, v7
    v_and_b32 v8, 0xffff0000, v92
    v_and_b32 v9, 0xffff0000, v172
    v_fmac_f32 v5, v8, v9
    v_lshlrev_b32 v6, 16, v93
    v_lshlrev_b32 v7, 16, v173
    v_fmac_f32 v4, v6, v7
    v_and_b32 v8, 0xffff0000, v93
    v_and_b32 v9, 0xffff0000, v173
    v_fmac_f32 v5, v8, v9
    v_lshlrev_b32 v6, 16, v94
    v_lshlrev_b32 v7, 16, v174
    v_fmac_f32 v4, v6, v7
    v_and_b32 v8, 0xffff0000, v94
    v_and_b32 v9, 0xffff0000, v174
    v_fmac_f32 v5, v8, v9
    v_lshlrev_b32 v6, 16, v95
    v_lshlrev_b32 v7, 16, v175
    v_fmac_f32 v4, v6, v7
    v_and_b32 v8, 0xffff0000, v95
    v_and_b32 v9, 0xffff0000, v175
    v_fmac_f32 v5, v8, v9
    v_add_f32 v4, v4, v5
    ds_swizzle_b32 v5, v4 offset:0x041F
    s_waitcnt lgkmcnt(0)
    v_add_f32 v4, v4, v5
    ds_swizzle_b32 v5, v4 offset:0x081F
    s_waitcnt lgkmcnt(0)
    v_add_f32 v4, v4, v5
    v_mul_f32 v4, 0xbfb8aa3b, v4
    v_exp_f32 v4, v4
    s_nop 0
    v_add_f32 v4, 1.0, v4
    v_rcp_f32 v4, v4
    v_lshlrev_b32 v5, 2, v1
    v_and_b32 v6, 3, v0
    v_cmp_eq_u32 vcc, 0, v6
    s_nop 1
    s_and_b64 exec, vcc, vcc
    s_mov_b32 s27, 25165824
    buffer_store_dword v4, v5, s[20:23], s27 offen
k1_exit:
    s_endpgm
.globl attn_kernel
.p2align 8
.type attn_kernel,@function
attn_kernel:
    s_cmp_ge_u32 s2, 256
    s_cbranch_scc1 k2_exit
    s_load_dwordx2 s[10:11], s[0:1], 72
    s_waitcnt lgkmcnt(0)
    s_mov_b32 s20, s10
    s_and_b32 s21, s11, 0xffff
    s_mov_b32 s22, 0x10000000
    s_mov_b32 s23, 0x00020000
    s_and_b32 s24, s2, 31
    s_lshr_b32 s25, s2, 5
    v_lshrrev_b32 v1, 6, v0
    s_nop 0
    v_readfirstlane_b32 s27, v1
    s_cmp_ge_u32 s25, 8
    s_cselect_b32 s26, 1, 0
    s_lshr_b32 s33, s27, 3
    s_and_b32 s34, s27, 7
    s_lshl_b32 s28, s25, 3
    s_add_u32 s28, s28, s34
    s_sub_u32 s35, s25, 8
    s_lshl_b32 s35, s35, 4
    s_add_u32 s36, s35, s27
    s_cmp_eq_u32 s26, 0
    s_cselect_b32 s28, s28, s36
    s_mov_b32 s29, 6291456
    s_cselect_b32 s29, 0, s29
    s_mov_b32 s30, 15728640
    s_cselect_b32 s30, 12582912, s30
    s_mov_b32 s31, 22020096
    s_cselect_b32 s31, 18874368, s31
    s_mul_i32 s32, s24, 167936
    s_add_u32 s29, s29, s32
    s_mul_i32 s32, s24, 81920
    s_add_u32 s30, s30, s32
    s_mul_i32 s32, s28, 1280
    s_add_u32 s30, s30, s32
    v_and_b32 v2, 63, v0
    v_and_b32 v3, 31, v2
    v_lshrrev_b32 v4, 5, v2
    v_lshlrev_b32 v5, 4, v2
    v_lshlrev_b32 v6, 2, v2
    buffer_load_dwordx4 v[16:19], v5, s[20:23], s30 offen
    buffer_load_dword v20, v6, s[20:23], s30 offen offset:1024
    v_mov_b32 v21, 0
    v_mov_b32 v101, 0
    v_mov_b32 v22, 0
    v_mov_b32 v102, 0
    v_mov_b32 v23, 0
    v_mov_b32 v103, 0
    v_add_u32 v6, 1024, v6
    v_min_u32 v7, 20, v3
    v_subrev_u32 v8, 24, v3
    v_cmp_le_u32 vcc, 28, v3
    s_nop 1
    v_cndmask_b32 v7, v7, v8, vcc
    v_lshlrev_b32 v7, 4, v7
    v_mul_u32_u24 v8, 336, v4
    v_add_u32 v7, v7, v8
    v_add_u32 v7, 1280, v7
    v_lshlrev_b32 v9, 4, v0
    s_mov_b32 s40, 0x42800000
    s_mov_b32 s41, s29
    buffer_load_dwordx4 v[112:115], v9, s[20:23], s41 offen
    s_add_u32 s41, s41, 16384
    buffer_load_dwordx4 v[116:119], v9, s[20:23], s41 offen
    s_add_u32 s41, s41, 16384
    buffer_load_dwordx4 v[120:123], v9, s[20:23], s41 offen
    s_mul_i32 s37, s33, 2624
    v_add_u32 v124, s37, v5
    v_add_u32 v125, s37, v6
    v_add_u32 v126, s37, v7
    v_add_u32 v10, 49152, v124
    v_add_u32 v11, 49152, v125
    v_add_u32 v8, 49152, v126
    s_waitcnt vmcnt(0)
    ds_write_b128 v9, v[112:115] offset:0
    ds_write_b128 v9, v[116:119] offset:16384
    ds_write_b128 v9, v[120:123] offset:32768
    s_waitcnt lgkmcnt(0)
    s_barrier
    ds_read_b128 v[96:99], v124 offset:0
    ds_read_b32 v100, v125 offset:0
    s_waitcnt lgkmcnt(0)
    v_mfma_f32_32x32x16_bf16 v[40:55], v[96:99], v[16:19], 0
    v_mfma_f32_32x32x16_bf16 v[40:55], v[100:103], v[20:23], v[40:55]
    s_nop 11
    v_max3_f32 v13, v40, v41, v42
    v_max3_f32 v14, v43, v44, v45
    v_max3_f32 v15, v46, v47, v48
    v_max3_f32 v1, v49, v50, v51
    v_max3_f32 v13, v13, v52, v53
    v_max3_f32 v14, v14, v54, v55
    v_max3_f32 v15, v15, v1, v13
    v_max_f32 v13, v15, v14
    v_mov_b32 v14, v13
    s_nop 1
    v_permlane32_swap_b32 v14, v13
    v_max_f32 v13, v13, v14
    v_mov_b32 v12, v13
    v_sub_f32 v24, 0, v13
    v_mov_b32 v80, 0
    v_sub_f32 v25, 0, v13
    v_mov_b32 v81, 0
    v_sub_f32 v26, 0, v13
    v_mov_b32 v82, 0
    v_sub_f32 v27, 0, v13
    v_mov_b32 v83, 0
    v_sub_f32 v28, 0, v13
    v_mov_b32 v84, 0
    v_sub_f32 v29, 0, v13
    v_mov_b32 v85, 0
    v_sub_f32 v30, 0, v13
    v_mov_b32 v86, 0
    v_sub_f32 v31, 0, v13
    v_mov_b32 v87, 0
    v_sub_f32 v32, 0, v13
    v_mov_b32 v88, 0
    v_sub_f32 v33, 0, v13
    v_mov_b32 v89, 0
    v_sub_f32 v34, 0, v13
    v_mov_b32 v90, 0
    v_sub_f32 v35, 0, v13
    v_mov_b32 v91, 0
    v_sub_f32 v36, 0, v13
    v_mov_b32 v92, 0
    v_sub_f32 v37, 0, v13
    v_mov_b32 v93, 0
    v_sub_f32 v38, 0, v13
    v_mov_b32 v94, 0
    v_sub_f32 v39, 0, v13
    v_mov_b32 v95, 0
    s_nop 0
    v_mfma_f32_32x32x16_bf16 v[40:55], v[96:99], v[16:19], v[24:39]
    v_mfma_f32_32x32x16_bf16 v[40:55], v[100:103], v[20:23], v[40:55]
    ds_read_b128 v[96:99], v124 offset:5248
    ds_read_b32 v100, v125 offset:5248
    ds_read_b128 v[104:107], v126 offset:0
    ds_read_b128 v[108:111], v126 offset:672
    s_nop 7
    v_max3_f32 v13, v40, v41, v42
    v_max3_f32 v14, v43, v44, v45
    v_max3_f32 v15, v46, v47, v48
    v_max3_f32 v1, v49, v50, v51
    v_max3_f32 v13, v13, v52, v53
    v_max3_f32 v14, v14, v54, v55
    v_max3_f32 v15, v15, v1, v13
    v_max_f32 v13, v15, v14
    v_cmp_lt_f32 vcc, s40, v13
    s_cbranch_vccz k2_f_11
    v_mov_b32 v14, v13
    s_nop 1
    v_permlane32_swap_b32 v14, v13
    v_max_f32 v13, v13, v14
    v_max_f32 v14, 0, v13
    v_add_f32 v12, v12, v14
    v_sub_f32 v15, 0, v14
    v_exp_f32 v15, v15
    v_sub_f32 v40, v40, v14
    v_sub_f32 v24, v24, v14
    v_mul_f32 v80, v80, v15
    v_sub_f32 v41, v41, v14
    v_sub_f32 v25, v25, v14
    v_mul_f32 v81, v81, v15
    v_sub_f32 v42, v42, v14
    v_sub_f32 v26, v26, v14
    v_mul_f32 v82, v82, v15
    v_sub_f32 v43, v43, v14
    v_sub_f32 v27, v27, v14
    v_mul_f32 v83, v83, v15
    v_sub_f32 v44, v44, v14
    v_sub_f32 v28, v28, v14
    v_mul_f32 v84, v84, v15
    v_sub_f32 v45, v45, v14
    v_sub_f32 v29, v29, v14
    v_mul_f32 v85, v85, v15
    v_sub_f32 v46, v46, v14
    v_sub_f32 v30, v30, v14
    v_mul_f32 v86, v86, v15
    v_sub_f32 v47, v47, v14
    v_sub_f32 v31, v31, v14
    v_mul_f32 v87, v87, v15
    v_sub_f32 v48, v48, v14
    v_sub_f32 v32, v32, v14
    v_mul_f32 v88, v88, v15
    v_sub_f32 v49, v49, v14
    v_sub_f32 v33, v33, v14
    v_mul_f32 v89, v89, v15
    v_sub_f32 v50, v50, v14
    v_sub_f32 v34, v34, v14
    v_mul_f32 v90, v90, v15
    v_sub_f32 v51, v51, v14
    v_sub_f32 v35, v35, v14
    v_mul_f32 v91, v91, v15
    v_sub_f32 v52, v52, v14
    v_sub_f32 v36, v36, v14
    v_mul_f32 v92, v92, v15
    v_sub_f32 v53, v53, v14
    v_sub_f32 v37, v37, v14
    v_mul_f32 v93, v93, v15
    v_sub_f32 v54, v54, v14
    v_sub_f32 v38, v38, v14
    v_mul_f32 v94, v94, v15
    v_sub_f32 v55, v55, v14
    v_sub_f32 v39, v39, v14
    v_mul_f32 v95, v95, v15
    s_nop 1
k2_f_11:
    s_mov_b32 s42, 0
    s_mov_b32 s43, 1
    s_lshl_b32 s35, s25, 3
    s_max_i32 s35, s35, 8
    s_sub_u32 s35, s35, 8
    s_mul_i32 s36, s35, 2624
    s_mul_i32 s38, s24, 167936
    s_add_u32 s36, s36, s38
    s_add_u32 s36, s36, 6291456
k2_chunk:
    s_add_u32 s44, s42, 1
    s_mul_i32 s44, s44, 41984
    s_add_u32 s44, s44, s29
    s_mov_b32 s41, s44
    buffer_load_dwordx4 v[112:115], v9, s[20:23], s41 offen
    s_add_u32 s41, s41, 16384
    buffer_load_dwordx4 v[116:119], v9, s[20:23], s41 offen
    s_add_u32 s41, s41, 16384
    buffer_load_dwordx4 v[120:123], v9, s[20:23], s41 offen
    s_mul_i32 s45, s43, 49152
    v_add_u32 v127, s45, v9
    s_waitcnt lgkmcnt(2)
    v_mfma_f32_32x32x16_bf16 v[56:71], v[96:99], v[16:19], v[24:39]
    v_exp_f32 v40, v40
    v_exp_f32 v41, v41
    v_exp_f32 v42, v42
    v_exp_f32 v43, v43
    v_mfma_f32_32x32x16_bf16 v[56:71], v[100:103], v[20:23], v[56:71]
    ds_read_b128 v[96:99], v124 offset:10496
    ds_read_b32 v100, v125 offset:10496
    v_exp_f32 v44, v44
    v_exp_f32 v45, v45
    v_exp_f32 v46, v46
    v_exp_f32 v47, v47
    v_cvt_pk_bf16_f32 v72, v40, v41
    v_cvt_pk_bf16_f32 v73, v42, v43
    v_cvt_pk_bf16_f32 v74, v44, v45
    v_cvt_pk_bf16_f32 v75, v46, v47
    s_waitcnt lgkmcnt(2)
    s_nop 0
    v_mfma_f32_32x32x16_bf16 v[80:95], v[104:107], v[72:75], v[80:95]
    v_exp_f32 v48, v48
    v_max3_f32 v13, v56, v57, v58
    v_exp_f32 v49, v49
    v_max3_f32 v14, v59, v60, v61
    v_exp_f32 v50, v50
    v_max3_f32 v15, v62, v63, v64
    v_exp_f32 v51, v51
    v_max3_f32 v1, v65, v66, v67
    v_exp_f32 v52, v52
    v_max3_f32 v13, v13, v68, v69
    v_exp_f32 v53, v53
    v_max3_f32 v14, v14, v70, v71
    v_exp_f32 v54, v54
    v_max3_f32 v15, v15, v1, v13
    v_exp_f32 v55, v55
    v_max_f32 v13, v15, v14
    v_cvt_pk_bf16_f32 v76, v48, v49
    v_cvt_pk_bf16_f32 v77, v50, v51
    v_cvt_pk_bf16_f32 v78, v52, v53
    v_cvt_pk_bf16_f32 v79, v54, v55
    v_cmp_lt_f32 vcc, s40, v13
    s_nop 0
    v_mfma_f32_32x32x16_bf16 v[80:95], v[108:111], v[76:79], v[80:95]
    ds_read_b128 v[104:107], v126 offset:5248
    ds_read_b128 v[108:111], v126 offset:5920
    s_cbranch_vccz k2_f_12
    v_mov_b32 v14, v13
    s_nop 1
    v_permlane32_swap_b32 v14, v13
    v_max_f32 v13, v13, v14
    v_max_f32 v14, 0, v13
    v_add_f32 v12, v12, v14
    v_sub_f32 v15, 0, v14
    v_exp_f32 v15, v15
    v_sub_f32 v56, v56, v14
    v_sub_f32 v24, v24, v14
    v_mul_f32 v80, v80, v15
    v_sub_f32 v57, v57, v14
    v_sub_f32 v25, v25, v14
    v_mul_f32 v81, v81, v15
    v_sub_f32 v58, v58, v14
    v_sub_f32 v26, v26, v14
    v_mul_f32 v82, v82, v15
    v_sub_f32 v59, v59, v14
    v_sub_f32 v27, v27, v14
    v_mul_f32 v83, v83, v15
    v_sub_f32 v60, v60, v14
    v_sub_f32 v28, v28, v14
    v_mul_f32 v84, v84, v15
    v_sub_f32 v61, v61, v14
    v_sub_f32 v29, v29, v14
    v_mul_f32 v85, v85, v15
    v_sub_f32 v62, v62, v14
    v_sub_f32 v30, v30, v14
    v_mul_f32 v86, v86, v15
    v_sub_f32 v63, v63, v14
    v_sub_f32 v31, v31, v14
    v_mul_f32 v87, v87, v15
    v_sub_f32 v64, v64, v14
    v_sub_f32 v32, v32, v14
    v_mul_f32 v88, v88, v15
    v_sub_f32 v65, v65, v14
    v_sub_f32 v33, v33, v14
    v_mul_f32 v89, v89, v15
    v_sub_f32 v66, v66, v14
    v_sub_f32 v34, v34, v14
    v_mul_f32 v90, v90, v15
    v_sub_f32 v67, v67, v14
    v_sub_f32 v35, v35, v14
    v_mul_f32 v91, v91, v15
    v_sub_f32 v68, v68, v14
    v_sub_f32 v36, v36, v14
    v_mul_f32 v92, v92, v15
    v_sub_f32 v69, v69, v14
    v_sub_f32 v37, v37, v14
    v_mul_f32 v93, v93, v15
    v_sub_f32 v70, v70, v14
    v_sub_f32 v38, v38, v14
    v_mul_f32 v94, v94, v15
    v_sub_f32 v71, v71, v14
    v_sub_f32 v39, v39, v14
    v_mul_f32 v95, v95, v15
    s_nop 1
k2_f_12:
    s_waitcnt lgkmcnt(2)
    v_mfma_f32_32x32x16_bf16 v[40:55], v[96:99], v[16:19], v[24:39]
    v_exp_f32 v56, v56
    v_exp_f32 v57, v57
    v_exp_f32 v58, v58
    v_exp_f32 v59, v59
    v_mfma_f32_32x32x16_bf16 v[40:55], v[100:103], v[20:23], v[40:55]
    ds_read_b128 v[96:99], v124 offset:15744
    ds_read_b32 v100, v125 offset:15744
    v_exp_f32 v60, v60
    v_exp_f32 v61, v61
    v_exp_f32 v62, v62
    v_exp_f32 v63, v63
    v_cvt_pk_bf16_f32 v72, v56, v57
    v_cvt_pk_bf16_f32 v73, v58, v59
    v_cvt_pk_bf16_f32 v74, v60, v61
    v_cvt_pk_bf16_f32 v75, v62, v63
    s_waitcnt lgkmcnt(2)
    s_nop 0
    v_mfma_f32_32x32x16_bf16 v[80:95], v[104:107], v[72:75], v[80:95]
    v_exp_f32 v64, v64
    v_max3_f32 v13, v40, v41, v42
    v_exp_f32 v65, v65
    v_max3_f32 v14, v43, v44, v45
    v_exp_f32 v66, v66
    v_max3_f32 v15, v46, v47, v48
    v_exp_f32 v67, v67
    v_max3_f32 v1, v49, v50, v51
    v_exp_f32 v68, v68
    v_max3_f32 v13, v13, v52, v53
    v_exp_f32 v69, v69
    v_max3_f32 v14, v14, v54, v55
    v_exp_f32 v70, v70
    v_max3_f32 v15, v15, v1, v13
    v_exp_f32 v71, v71
    v_max_f32 v13, v15, v14
    v_cvt_pk_bf16_f32 v76, v64, v65
    v_cvt_pk_bf16_f32 v77, v66, v67
    v_cvt_pk_bf16_f32 v78, v68, v69
    v_cvt_pk_bf16_f32 v79, v70, v71
    v_cmp_lt_f32 vcc, s40, v13
    s_nop 0
    v_mfma_f32_32x32x16_bf16 v[80:95], v[108:111], v[76:79], v[80:95]
    ds_read_b128 v[104:107], v126 offset:10496
    ds_read_b128 v[108:111], v126 offset:11168
    s_cbranch_vccz k2_f_13
    v_mov_b32 v14, v13
    s_nop 1
    v_permlane32_swap_b32 v14, v13
    v_max_f32 v13, v13, v14
    v_max_f32 v14, 0, v13
    v_add_f32 v12, v12, v14
    v_sub_f32 v15, 0, v14
    v_exp_f32 v15, v15
    v_sub_f32 v40, v40, v14
    v_sub_f32 v24, v24, v14
    v_mul_f32 v80, v80, v15
    v_sub_f32 v41, v41, v14
    v_sub_f32 v25, v25, v14
    v_mul_f32 v81, v81, v15
    v_sub_f32 v42, v42, v14
    v_sub_f32 v26, v26, v14
    v_mul_f32 v82, v82, v15
    v_sub_f32 v43, v43, v14
    v_sub_f32 v27, v27, v14
    v_mul_f32 v83, v83, v15
    v_sub_f32 v44, v44, v14
    v_sub_f32 v28, v28, v14
    v_mul_f32 v84, v84, v15
    v_sub_f32 v45, v45, v14
    v_sub_f32 v29, v29, v14
    v_mul_f32 v85, v85, v15
    v_sub_f32 v46, v46, v14
    v_sub_f32 v30, v30, v14
    v_mul_f32 v86, v86, v15
    v_sub_f32 v47, v47, v14
    v_sub_f32 v31, v31, v14
    v_mul_f32 v87, v87, v15
    v_sub_f32 v48, v48, v14
    v_sub_f32 v32, v32, v14
    v_mul_f32 v88, v88, v15
    v_sub_f32 v49, v49, v14
    v_sub_f32 v33, v33, v14
    v_mul_f32 v89, v89, v15
    v_sub_f32 v50, v50, v14
    v_sub_f32 v34, v34, v14
    v_mul_f32 v90, v90, v15
    v_sub_f32 v51, v51, v14
    v_sub_f32 v35, v35, v14
    v_mul_f32 v91, v91, v15
    v_sub_f32 v52, v52, v14
    v_sub_f32 v36, v36, v14
    v_mul_f32 v92, v92, v15
    v_sub_f32 v53, v53, v14
    v_sub_f32 v37, v37, v14
    v_mul_f32 v93, v93, v15
    v_sub_f32 v54, v54, v14
    v_sub_f32 v38, v38, v14
    v_mul_f32 v94, v94, v15
    v_sub_f32 v55, v55, v14
    v_sub_f32 v39, v39, v14
    v_mul_f32 v95, v95, v15
    s_nop 1
k2_f_13:
    s_waitcnt lgkmcnt(2)
    v_mfma_f32_32x32x16_bf16 v[56:71], v[96:99], v[16:19], v[24:39]
    v_exp_f32 v40, v40
    v_exp_f32 v41, v41
    v_exp_f32 v42, v42
    v_exp_f32 v43, v43
    v_mfma_f32_32x32x16_bf16 v[56:71], v[100:103], v[20:23], v[56:71]
    ds_read_b128 v[96:99], v124 offset:20992
    ds_read_b32 v100, v125 offset:20992
    v_exp_f32 v44, v44
    v_exp_f32 v45, v45
    v_exp_f32 v46, v46
    v_exp_f32 v47, v47
    v_cvt_pk_bf16_f32 v72, v40, v41
    v_cvt_pk_bf16_f32 v73, v42, v43
    v_cvt_pk_bf16_f32 v74, v44, v45
    v_cvt_pk_bf16_f32 v75, v46, v47
    s_waitcnt lgkmcnt(2)
    s_nop 0
    v_mfma_f32_32x32x16_bf16 v[80:95], v[104:107], v[72:75], v[80:95]
    v_exp_f32 v48, v48
    v_max3_f32 v13, v56, v57, v58
    v_exp_f32 v49, v49
    v_max3_f32 v14, v59, v60, v61
    v_exp_f32 v50, v50
    v_max3_f32 v15, v62, v63, v64
    v_exp_f32 v51, v51
    v_max3_f32 v1, v65, v66, v67
    v_exp_f32 v52, v52
    v_max3_f32 v13, v13, v68, v69
    v_exp_f32 v53, v53
    v_max3_f32 v14, v14, v70, v71
    v_exp_f32 v54, v54
    v_max3_f32 v15, v15, v1, v13
    v_exp_f32 v55, v55
    v_max_f32 v13, v15, v14
    v_cvt_pk_bf16_f32 v76, v48, v49
    v_cvt_pk_bf16_f32 v77, v50, v51
    v_cvt_pk_bf16_f32 v78, v52, v53
    v_cvt_pk_bf16_f32 v79, v54, v55
    v_cmp_lt_f32 vcc, s40, v13
    s_nop 0
    v_mfma_f32_32x32x16_bf16 v[80:95], v[108:111], v[76:79], v[80:95]
    ds_read_b128 v[104:107], v126 offset:15744
    ds_read_b128 v[108:111], v126 offset:16416
    s_cbranch_vccz k2_f_14
    v_mov_b32 v14, v13
    s_nop 1
    v_permlane32_swap_b32 v14, v13
    v_max_f32 v13, v13, v14
    v_max_f32 v14, 0, v13
    v_add_f32 v12, v12, v14
    v_sub_f32 v15, 0, v14
    v_exp_f32 v15, v15
    v_sub_f32 v56, v56, v14
    v_sub_f32 v24, v24, v14
    v_mul_f32 v80, v80, v15
    v_sub_f32 v57, v57, v14
    v_sub_f32 v25, v25, v14
    v_mul_f32 v81, v81, v15
    v_sub_f32 v58, v58, v14
    v_sub_f32 v26, v26, v14
    v_mul_f32 v82, v82, v15
    v_sub_f32 v59, v59, v14
    v_sub_f32 v27, v27, v14
    v_mul_f32 v83, v83, v15
    v_sub_f32 v60, v60, v14
    v_sub_f32 v28, v28, v14
    v_mul_f32 v84, v84, v15
    v_sub_f32 v61, v61, v14
    v_sub_f32 v29, v29, v14
    v_mul_f32 v85, v85, v15
    v_sub_f32 v62, v62, v14
    v_sub_f32 v30, v30, v14
    v_mul_f32 v86, v86, v15
    v_sub_f32 v63, v63, v14
    v_sub_f32 v31, v31, v14
    v_mul_f32 v87, v87, v15
    v_sub_f32 v64, v64, v14
    v_sub_f32 v32, v32, v14
    v_mul_f32 v88, v88, v15
    v_sub_f32 v65, v65, v14
    v_sub_f32 v33, v33, v14
    v_mul_f32 v89, v89, v15
    v_sub_f32 v66, v66, v14
    v_sub_f32 v34, v34, v14
    v_mul_f32 v90, v90, v15
    v_sub_f32 v67, v67, v14
    v_sub_f32 v35, v35, v14
    v_mul_f32 v91, v91, v15
    v_sub_f32 v68, v68, v14
    v_sub_f32 v36, v36, v14
    v_mul_f32 v92, v92, v15
    v_sub_f32 v69, v69, v14
    v_sub_f32 v37, v37, v14
    v_mul_f32 v93, v93, v15
    v_sub_f32 v70, v70, v14
    v_sub_f32 v38, v38, v14
    v_mul_f32 v94, v94, v15
    v_sub_f32 v71, v71, v14
    v_sub_f32 v39, v39, v14
    v_mul_f32 v95, v95, v15
    s_nop 1
k2_f_14:
    s_waitcnt lgkmcnt(2)
    v_mfma_f32_32x32x16_bf16 v[40:55], v[96:99], v[16:19], v[24:39]
    v_exp_f32 v56, v56
    v_exp_f32 v57, v57
    v_exp_f32 v58, v58
    v_exp_f32 v59, v59
    v_mfma_f32_32x32x16_bf16 v[40:55], v[100:103], v[20:23], v[40:55]
    ds_read_b128 v[96:99], v124 offset:26240
    ds_read_b32 v100, v125 offset:26240
    v_exp_f32 v60, v60
    v_exp_f32 v61, v61
    v_exp_f32 v62, v62
    v_exp_f32 v63, v63
    v_cvt_pk_bf16_f32 v72, v56, v57
    v_cvt_pk_bf16_f32 v73, v58, v59
    v_cvt_pk_bf16_f32 v74, v60, v61
    v_cvt_pk_bf16_f32 v75, v62, v63
    s_waitcnt lgkmcnt(2)
    s_nop 0
    v_mfma_f32_32x32x16_bf16 v[80:95], v[104:107], v[72:75], v[80:95]
    v_exp_f32 v64, v64
    v_max3_f32 v13, v40, v41, v42
    v_exp_f32 v65, v65
    v_max3_f32 v14, v43, v44, v45
    v_exp_f32 v66, v66
    v_max3_f32 v15, v46, v47, v48
    v_exp_f32 v67, v67
    v_max3_f32 v1, v49, v50, v51
    v_exp_f32 v68, v68
    v_max3_f32 v13, v13, v52, v53
    v_exp_f32 v69, v69
    v_max3_f32 v14, v14, v54, v55
    v_exp_f32 v70, v70
    v_max3_f32 v15, v15, v1, v13
    v_exp_f32 v71, v71
    v_max_f32 v13, v15, v14
    v_cvt_pk_bf16_f32 v76, v64, v65
    v_cvt_pk_bf16_f32 v77, v66, v67
    v_cvt_pk_bf16_f32 v78, v68, v69
    v_cvt_pk_bf16_f32 v79, v70, v71
    v_cmp_lt_f32 vcc, s40, v13
    s_nop 0
    v_mfma_f32_32x32x16_bf16 v[80:95], v[108:111], v[76:79], v[80:95]
    ds_read_b128 v[104:107], v126 offset:20992
    ds_read_b128 v[108:111], v126 offset:21664
    s_cbranch_vccz k2_f_15
    v_mov_b32 v14, v13
    s_nop 1
    v_permlane32_swap_b32 v14, v13
    v_max_f32 v13, v13, v14
    v_max_f32 v14, 0, v13
    v_add_f32 v12, v12, v14
    v_sub_f32 v15, 0, v14
    v_exp_f32 v15, v15
    v_sub_f32 v40, v40, v14
    v_sub_f32 v24, v24, v14
    v_mul_f32 v80, v80, v15
    v_sub_f32 v41, v41, v14
    v_sub_f32 v25, v25, v14
    v_mul_f32 v81, v81, v15
    v_sub_f32 v42, v42, v14
    v_sub_f32 v26, v26, v14
    v_mul_f32 v82, v82, v15
    v_sub_f32 v43, v43, v14
    v_sub_f32 v27, v27, v14
    v_mul_f32 v83, v83, v15
    v_sub_f32 v44, v44, v14
    v_sub_f32 v28, v28, v14
    v_mul_f32 v84, v84, v15
    v_sub_f32 v45, v45, v14
    v_sub_f32 v29, v29, v14
    v_mul_f32 v85, v85, v15
    v_sub_f32 v46, v46, v14
    v_sub_f32 v30, v30, v14
    v_mul_f32 v86, v86, v15
    v_sub_f32 v47, v47, v14
    v_sub_f32 v31, v31, v14
    v_mul_f32 v87, v87, v15
    v_sub_f32 v48, v48, v14
    v_sub_f32 v32, v32, v14
    v_mul_f32 v88, v88, v15
    v_sub_f32 v49, v49, v14
    v_sub_f32 v33, v33, v14
    v_mul_f32 v89, v89, v15
    v_sub_f32 v50, v50, v14
    v_sub_f32 v34, v34, v14
    v_mul_f32 v90, v90, v15
    v_sub_f32 v51, v51, v14
    v_sub_f32 v35, v35, v14
    v_mul_f32 v91, v91, v15
    v_sub_f32 v52, v52, v14
    v_sub_f32 v36, v36, v14
    v_mul_f32 v92, v92, v15
    v_sub_f32 v53, v53, v14
    v_sub_f32 v37, v37, v14
    v_mul_f32 v93, v93, v15
    v_sub_f32 v54, v54, v14
    v_sub_f32 v38, v38, v14
    v_mul_f32 v94, v94, v15
    v_sub_f32 v55, v55, v14
    v_sub_f32 v39, v39, v14
    v_mul_f32 v95, v95, v15
    s_nop 1
k2_f_15:
    s_waitcnt vmcnt(0)
    ds_write_b128 v127, v[112:115] offset:0
    ds_write_b128 v127, v[116:119] offset:16384
    ds_write_b128 v127, v[120:123] offset:32768
    s_waitcnt lgkmcnt(5)
    v_mfma_f32_32x32x16_bf16 v[56:71], v[96:99], v[16:19], v[24:39]
    v_exp_f32 v40, v40
    v_exp_f32 v41, v41
    v_exp_f32 v42, v42
    v_exp_f32 v43, v43
    v_mfma_f32_32x32x16_bf16 v[56:71], v[100:103], v[20:23], v[56:71]
    ds_read_b128 v[96:99], v124 offset:31488
    ds_read_b32 v100, v125 offset:31488
    v_exp_f32 v44, v44
    v_exp_f32 v45, v45
    v_exp_f32 v46, v46
    v_exp_f32 v47, v47
    v_cvt_pk_bf16_f32 v72, v40, v41
    v_cvt_pk_bf16_f32 v73, v42, v43
    v_cvt_pk_bf16_f32 v74, v44, v45
    v_cvt_pk_bf16_f32 v75, v46, v47
    s_waitcnt lgkmcnt(5)
    s_nop 0
    v_mfma_f32_32x32x16_bf16 v[80:95], v[104:107], v[72:75], v[80:95]
    v_exp_f32 v48, v48
    v_max3_f32 v13, v56, v57, v58
    v_exp_f32 v49, v49
    v_max3_f32 v14, v59, v60, v61
    v_exp_f32 v50, v50
    v_max3_f32 v15, v62, v63, v64
    v_exp_f32 v51, v51
    v_max3_f32 v1, v65, v66, v67
    v_exp_f32 v52, v52
    v_max3_f32 v13, v13, v68, v69
    v_exp_f32 v53, v53
    v_max3_f32 v14, v14, v70, v71
    v_exp_f32 v54, v54
    v_max3_f32 v15, v15, v1, v13
    v_exp_f32 v55, v55
    v_max_f32 v13, v15, v14
    v_cvt_pk_bf16_f32 v76, v48, v49
    v_cvt_pk_bf16_f32 v77, v50, v51
    v_cvt_pk_bf16_f32 v78, v52, v53
    v_cvt_pk_bf16_f32 v79, v54, v55
    v_cmp_lt_f32 vcc, s40, v13
    s_nop 0
    v_mfma_f32_32x32x16_bf16 v[80:95], v[108:111], v[76:79], v[80:95]
    ds_read_b128 v[104:107], v126 offset:26240
    ds_read_b128 v[108:111], v126 offset:26912
    s_cbranch_vccz k2_f_16
    v_mov_b32 v14, v13
    s_nop 1
    v_permlane32_swap_b32 v14, v13
    v_max_f32 v13, v13, v14
    v_max_f32 v14, 0, v13
    v_add_f32 v12, v12, v14
    v_sub_f32 v15, 0, v14
    v_exp_f32 v15, v15
    v_sub_f32 v56, v56, v14
    v_sub_f32 v24, v24, v14
    v_mul_f32 v80, v80, v15
    v_sub_f32 v57, v57, v14
    v_sub_f32 v25, v25, v14
    v_mul_f32 v81, v81, v15
    v_sub_f32 v58, v58, v14
    v_sub_f32 v26, v26, v14
    v_mul_f32 v82, v82, v15
    v_sub_f32 v59, v59, v14
    v_sub_f32 v27, v27, v14
    v_mul_f32 v83, v83, v15
    v_sub_f32 v60, v60, v14
    v_sub_f32 v28, v28, v14
    v_mul_f32 v84, v84, v15
    v_sub_f32 v61, v61, v14
    v_sub_f32 v29, v29, v14
    v_mul_f32 v85, v85, v15
    v_sub_f32 v62, v62, v14
    v_sub_f32 v30, v30, v14
    v_mul_f32 v86, v86, v15
    v_sub_f32 v63, v63, v14
    v_sub_f32 v31, v31, v14
    v_mul_f32 v87, v87, v15
    v_sub_f32 v64, v64, v14
    v_sub_f32 v32, v32, v14
    v_mul_f32 v88, v88, v15
    v_sub_f32 v65, v65, v14
    v_sub_f32 v33, v33, v14
    v_mul_f32 v89, v89, v15
    v_sub_f32 v66, v66, v14
    v_sub_f32 v34, v34, v14
    v_mul_f32 v90, v90, v15
    v_sub_f32 v67, v67, v14
    v_sub_f32 v35, v35, v14
    v_mul_f32 v91, v91, v15
    v_sub_f32 v68, v68, v14
    v_sub_f32 v36, v36, v14
    v_mul_f32 v92, v92, v15
    v_sub_f32 v69, v69, v14
    v_sub_f32 v37, v37, v14
    v_mul_f32 v93, v93, v15
    v_sub_f32 v70, v70, v14
    v_sub_f32 v38, v38, v14
    v_mul_f32 v94, v94, v15
    v_sub_f32 v71, v71, v14
    v_sub_f32 v39, v39, v14
    v_mul_f32 v95, v95, v15
    s_nop 1
k2_f_16:
    s_waitcnt lgkmcnt(2)
    v_mfma_f32_32x32x16_bf16 v[40:55], v[96:99], v[16:19], v[24:39]
    v_exp_f32 v56, v56
    v_exp_f32 v57, v57
    v_exp_f32 v58, v58
    v_exp_f32 v59, v59
    v_mfma_f32_32x32x16_bf16 v[40:55], v[100:103], v[20:23], v[40:55]
    ds_read_b128 v[96:99], v124 offset:36736
    ds_read_b32 v100, v125 offset:36736
    v_exp_f32 v60, v60
    v_exp_f32 v61, v61
    v_exp_f32 v62, v62
    v_exp_f32 v63, v63
    v_cvt_pk_bf16_f32 v72, v56, v57
    v_cvt_pk_bf16_f32 v73, v58, v59
    v_cvt_pk_bf16_f32 v74, v60, v61
    v_cvt_pk_bf16_f32 v75, v62, v63
    s_waitcnt lgkmcnt(2)
    s_nop 0
    v_mfma_f32_32x32x16_bf16 v[80:95], v[104:107], v[72:75], v[80:95]
    v_exp_f32 v64, v64
    v_max3_f32 v13, v40, v41, v42
    v_exp_f32 v65, v65
    v_max3_f32 v14, v43, v44, v45
    v_exp_f32 v66, v66
    v_max3_f32 v15, v46, v47, v48
    v_exp_f32 v67, v67
    v_max3_f32 v1, v49, v50, v51
    v_exp_f32 v68, v68
    v_max3_f32 v13, v13, v52, v53
    v_exp_f32 v69, v69
    v_max3_f32 v14, v14, v54, v55
    v_exp_f32 v70, v70
    v_max3_f32 v15, v15, v1, v13
    v_exp_f32 v71, v71
    v_max_f32 v13, v15, v14
    v_cvt_pk_bf16_f32 v76, v64, v65
    v_cvt_pk_bf16_f32 v77, v66, v67
    v_cvt_pk_bf16_f32 v78, v68, v69
    v_cvt_pk_bf16_f32 v79, v70, v71
    v_cmp_lt_f32 vcc, s40, v13
    s_nop 0
    v_mfma_f32_32x32x16_bf16 v[80:95], v[108:111], v[76:79], v[80:95]
    ds_read_b128 v[104:107], v126 offset:31488
    ds_read_b128 v[108:111], v126 offset:32160
    s_cbranch_vccz k2_f_17
    v_mov_b32 v14, v13
    s_nop 1
    v_permlane32_swap_b32 v14, v13
    v_max_f32 v13, v13, v14
    v_max_f32 v14, 0, v13
    v_add_f32 v12, v12, v14
    v_sub_f32 v15, 0, v14
    v_exp_f32 v15, v15
    v_sub_f32 v40, v40, v14
    v_sub_f32 v24, v24, v14
    v_mul_f32 v80, v80, v15
    v_sub_f32 v41, v41, v14
    v_sub_f32 v25, v25, v14
    v_mul_f32 v81, v81, v15
    v_sub_f32 v42, v42, v14
    v_sub_f32 v26, v26, v14
    v_mul_f32 v82, v82, v15
    v_sub_f32 v43, v43, v14
    v_sub_f32 v27, v27, v14
    v_mul_f32 v83, v83, v15
    v_sub_f32 v44, v44, v14
    v_sub_f32 v28, v28, v14
    v_mul_f32 v84, v84, v15
    v_sub_f32 v45, v45, v14
    v_sub_f32 v29, v29, v14
    v_mul_f32 v85, v85, v15
    v_sub_f32 v46, v46, v14
    v_sub_f32 v30, v30, v14
    v_mul_f32 v86, v86, v15
    v_sub_f32 v47, v47, v14
    v_sub_f32 v31, v31, v14
    v_mul_f32 v87, v87, v15
    v_sub_f32 v48, v48, v14
    v_sub_f32 v32, v32, v14
    v_mul_f32 v88, v88, v15
    v_sub_f32 v49, v49, v14
    v_sub_f32 v33, v33, v14
    v_mul_f32 v89, v89, v15
    v_sub_f32 v50, v50, v14
    v_sub_f32 v34, v34, v14
    v_mul_f32 v90, v90, v15
    v_sub_f32 v51, v51, v14
    v_sub_f32 v35, v35, v14
    v_mul_f32 v91, v91, v15
    v_sub_f32 v52, v52, v14
    v_sub_f32 v36, v36, v14
    v_mul_f32 v92, v92, v15
    v_sub_f32 v53, v53, v14
    v_sub_f32 v37, v37, v14
    v_mul_f32 v93, v93, v15
    v_sub_f32 v54, v54, v14
    v_sub_f32 v38, v38, v14
    v_mul_f32 v94, v94, v15
    v_sub_f32 v55, v55, v14
    v_sub_f32 v39, v39, v14
    v_mul_f32 v95, v95, v15
    s_nop 1
k2_f_17:
    s_barrier
    s_waitcnt lgkmcnt(2)
    v_mfma_f32_32x32x16_bf16 v[56:71], v[96:99], v[16:19], v[24:39]
    v_exp_f32 v40, v40
    v_exp_f32 v41, v41
    v_exp_f32 v42, v42
    v_exp_f32 v43, v43
    v_mfma_f32_32x32x16_bf16 v[56:71], v[100:103], v[20:23], v[56:71]
    ds_read_b128 v[96:99], v10 offset:0
    ds_read_b32 v100, v11 offset:0
    v_exp_f32 v44, v44
    v_exp_f32 v45, v45
    v_exp_f32 v46, v46
    v_exp_f32 v47, v47
    v_cvt_pk_bf16_f32 v72, v40, v41
    v_cvt_pk_bf16_f32 v73, v42, v43
    v_cvt_pk_bf16_f32 v74, v44, v45
    v_cvt_pk_bf16_f32 v75, v46, v47
    s_waitcnt lgkmcnt(2)
    s_nop 0
    v_mfma_f32_32x32x16_bf16 v[80:95], v[104:107], v[72:75], v[80:95]
    v_exp_f32 v48, v48
    v_max3_f32 v13, v56, v57, v58
    v_exp_f32 v49, v49
    v_max3_f32 v14, v59, v60, v61
    v_exp_f32 v50, v50
    v_max3_f32 v15, v62, v63, v64
    v_exp_f32 v51, v51
    v_max3_f32 v1, v65, v66, v67
    v_exp_f32 v52, v52
    v_max3_f32 v13, v13, v68, v69
    v_exp_f32 v53, v53
    v_max3_f32 v14, v14, v70, v71
    v_exp_f32 v54, v54
    v_max3_f32 v15, v15, v1, v13
    v_exp_f32 v55, v55
    v_max_f32 v13, v15, v14
    v_cvt_pk_bf16_f32 v76, v48, v49
    v_cvt_pk_bf16_f32 v77, v50, v51
    v_cvt_pk_bf16_f32 v78, v52, v53
    v_cvt_pk_bf16_f32 v79, v54, v55
    v_cmp_lt_f32 vcc, s40, v13
    s_nop 0
    v_mfma_f32_32x32x16_bf16 v[80:95], v[108:111], v[76:79], v[80:95]
    ds_read_b128 v[104:107], v126 offset:36736
    ds_read_b128 v[108:111], v126 offset:37408
    s_cbranch_vccz k2_f_18
    v_mov_b32 v14, v13
    s_nop 1
    v_permlane32_swap_b32 v14, v13
    v_max_f32 v13, v13, v14
    v_max_f32 v14, 0, v13
    v_add_f32 v12, v12, v14
    v_sub_f32 v15, 0, v14
    v_exp_f32 v15, v15
    v_sub_f32 v56, v56, v14
    v_sub_f32 v24, v24, v14
    v_mul_f32 v80, v80, v15
    v_sub_f32 v57, v57, v14
    v_sub_f32 v25, v25, v14
    v_mul_f32 v81, v81, v15
    v_sub_f32 v58, v58, v14
    v_sub_f32 v26, v26, v14
    v_mul_f32 v82, v82, v15
    v_sub_f32 v59, v59, v14
    v_sub_f32 v27, v27, v14
    v_mul_f32 v83, v83, v15
    v_sub_f32 v60, v60, v14
    v_sub_f32 v28, v28, v14
    v_mul_f32 v84, v84, v15
    v_sub_f32 v61, v61, v14
    v_sub_f32 v29, v29, v14
    v_mul_f32 v85, v85, v15
    v_sub_f32 v62, v62, v14
    v_sub_f32 v30, v30, v14
    v_mul_f32 v86, v86, v15
    v_sub_f32 v63, v63, v14
    v_sub_f32 v31, v31, v14
    v_mul_f32 v87, v87, v15
    v_sub_f32 v64, v64, v14
    v_sub_f32 v32, v32, v14
    v_mul_f32 v88, v88, v15
    v_sub_f32 v65, v65, v14
    v_sub_f32 v33, v33, v14
    v_mul_f32 v89, v89, v15
    v_sub_f32 v66, v66, v14
    v_sub_f32 v34, v34, v14
    v_mul_f32 v90, v90, v15
    v_sub_f32 v67, v67, v14
    v_sub_f32 v35, v35, v14
    v_mul_f32 v91, v91, v15
    v_sub_f32 v68, v68, v14
    v_sub_f32 v36, v36, v14
    v_mul_f32 v92, v92, v15
    v_sub_f32 v69, v69, v14
    v_sub_f32 v37, v37, v14
    v_mul_f32 v93, v93, v15
    v_sub_f32 v70, v70, v14
    v_sub_f32 v38, v38, v14
    v_mul_f32 v94, v94, v15
    v_sub_f32 v71, v71, v14
    v_sub_f32 v39, v39, v14
    v_mul_f32 v95, v95, v15
    s_nop 1
k2_f_18:
    s_waitcnt lgkmcnt(2)
    v_mfma_f32_32x32x16_bf16 v[40:55], v[96:99], v[16:19], v[24:39]
    v_exp_f32 v56, v56
    v_exp_f32 v57, v57
    v_exp_f32 v58, v58
    v_exp_f32 v59, v59
    v_mfma_f32_32x32x16_bf16 v[40:55], v[100:103], v[20:23], v[40:55]
    ds_read_b128 v[96:99], v10 offset:5248
    ds_read_b32 v100, v11 offset:5248
    v_exp_f32 v60, v60
    v_exp_f32 v61, v61
    v_exp_f32 v62, v62
    v_exp_f32 v63, v63
    v_cvt_pk_bf16_f32 v72, v56, v57
    v_cvt_pk_bf16_f32 v73, v58, v59
    v_cvt_pk_bf16_f32 v74, v60, v61
    v_cvt_pk_bf16_f32 v75, v62, v63
    s_waitcnt lgkmcnt(2)
    s_nop 0
    v_mfma_f32_32x32x16_bf16 v[80:95], v[104:107], v[72:75], v[80:95]
    v_exp_f32 v64, v64
    v_max3_f32 v13, v40, v41, v42
    v_exp_f32 v65, v65
    v_max3_f32 v14, v43, v44, v45
    v_exp_f32 v66, v66
    v_max3_f32 v15, v46, v47, v48
    v_exp_f32 v67, v67
    v_max3_f32 v1, v49, v50, v51
    v_exp_f32 v68, v68
    v_max3_f32 v13, v13, v52, v53
    v_exp_f32 v69, v69
    v_max3_f32 v14, v14, v54, v55
    v_exp_f32 v70, v70
    v_max3_f32 v15, v15, v1, v13
    v_exp_f32 v71, v71
    v_max_f32 v13, v15, v14
    v_cvt_pk_bf16_f32 v76, v64, v65
    v_cvt_pk_bf16_f32 v77, v66, v67
    v_cvt_pk_bf16_f32 v78, v68, v69
    v_cvt_pk_bf16_f32 v79, v70, v71
    v_cmp_lt_f32 vcc, s40, v13
    s_nop 0
    v_mfma_f32_32x32x16_bf16 v[80:95], v[108:111], v[76:79], v[80:95]
    ds_read_b128 v[104:107], v8 offset:0
    ds_read_b128 v[108:111], v8 offset:672
    s_cbranch_vccz k2_f_19
    v_mov_b32 v14, v13
    s_nop 1
    v_permlane32_swap_b32 v14, v13
    v_max_f32 v13, v13, v14
    v_max_f32 v14, 0, v13
    v_add_f32 v12, v12, v14
    v_sub_f32 v15, 0, v14
    v_exp_f32 v15, v15
    v_sub_f32 v40, v40, v14
    v_sub_f32 v24, v24, v14
    v_mul_f32 v80, v80, v15
    v_sub_f32 v41, v41, v14
    v_sub_f32 v25, v25, v14
    v_mul_f32 v81, v81, v15
    v_sub_f32 v42, v42, v14
    v_sub_f32 v26, v26, v14
    v_mul_f32 v82, v82, v15
    v_sub_f32 v43, v43, v14
    v_sub_f32 v27, v27, v14
    v_mul_f32 v83, v83, v15
    v_sub_f32 v44, v44, v14
    v_sub_f32 v28, v28, v14
    v_mul_f32 v84, v84, v15
    v_sub_f32 v45, v45, v14
    v_sub_f32 v29, v29, v14
    v_mul_f32 v85, v85, v15
    v_sub_f32 v46, v46, v14
    v_sub_f32 v30, v30, v14
    v_mul_f32 v86, v86, v15
    v_sub_f32 v47, v47, v14
    v_sub_f32 v31, v31, v14
    v_mul_f32 v87, v87, v15
    v_sub_f32 v48, v48, v14
    v_sub_f32 v32, v32, v14
    v_mul_f32 v88, v88, v15
    v_sub_f32 v49, v49, v14
    v_sub_f32 v33, v33, v14
    v_mul_f32 v89, v89, v15
    v_sub_f32 v50, v50, v14
    v_sub_f32 v34, v34, v14
    v_mul_f32 v90, v90, v15
    v_sub_f32 v51, v51, v14
    v_sub_f32 v35, v35, v14
    v_mul_f32 v91, v91, v15
    v_sub_f32 v52, v52, v14
    v_sub_f32 v36, v36, v14
    v_mul_f32 v92, v92, v15
    v_sub_f32 v53, v53, v14
    v_sub_f32 v37, v37, v14
    v_mul_f32 v93, v93, v15
    v_sub_f32 v54, v54, v14
    v_sub_f32 v38, v38, v14
    v_mul_f32 v94, v94, v15
    v_sub_f32 v55, v55, v14
    v_sub_f32 v39, v39, v14
    v_mul_f32 v95, v95, v15
    s_nop 1
k2_f_19:
    v_mov_b32 v124, v10
    v_mov_b32 v125, v11
    v_mov_b32 v126, v8
    s_add_u32 s42, s42, 1
    s_add_u32 s43, s43, 1
    s_cmp_ge_u32 s43, 3
    s_cselect_b32 s43, 0, s43
    s_mul_i32 s45, s43, 49152
    s_add_u32 s45, s45, s37
    v_add_u32 v10, s45, v5
    v_add_u32 v11, s45, v6
    v_add_u32 v8, s45, v7
    s_cmp_lt_u32 s42, 3
    s_nop 0
    s_cbranch_scc1 k2_chunk
    s_mov_b32 s41, s36
    buffer_load_dwordx4 v[112:115], v9, s[20:23], s41 offen
    s_add_u32 s41, s41, 16384
    buffer_load_dwordx4 v[116:119], v9, s[20:23], s41 offen
    s_add_u32 s41, s41, 16384
    buffer_load_dwordx4 v[120:123], v9, s[20:23], s41 offen
    s_mul_i32 s45, s43, 49152
    v_add_u32 v127, s45, v9
    s_waitcnt lgkmcnt(2)
    v_mfma_f32_32x32x16_bf16 v[56:71], v[96:99], v[16:19], v[24:39]
    v_exp_f32 v40, v40
    v_exp_f32 v41, v41
    v_exp_f32 v42, v42
    v_exp_f32 v43, v43
    v_mfma_f32_32x32x16_bf16 v[56:71], v[100:103], v[20:23], v[56:71]
    ds_read_b128 v[96:99], v124 offset:10496
    ds_read_b32 v100, v125 offset:10496
    v_exp_f32 v44, v44
    v_exp_f32 v45, v45
    v_exp_f32 v46, v46
    v_exp_f32 v47, v47
    v_cvt_pk_bf16_f32 v72, v40, v41
    v_cvt_pk_bf16_f32 v73, v42, v43
    v_cvt_pk_bf16_f32 v74, v44, v45
    v_cvt_pk_bf16_f32 v75, v46, v47
    s_waitcnt lgkmcnt(2)
    s_nop 0
    v_mfma_f32_32x32x16_bf16 v[80:95], v[104:107], v[72:75], v[80:95]
    v_exp_f32 v48, v48
    v_max3_f32 v13, v56, v57, v58
    v_exp_f32 v49, v49
    v_max3_f32 v14, v59, v60, v61
    v_exp_f32 v50, v50
    v_max3_f32 v15, v62, v63, v64
    v_exp_f32 v51, v51
    v_max3_f32 v1, v65, v66, v67
    v_exp_f32 v52, v52
    v_max3_f32 v13, v13, v68, v69
    v_exp_f32 v53, v53
    v_max3_f32 v14, v14, v70, v71
    v_exp_f32 v54, v54
    v_max3_f32 v15, v15, v1, v13
    v_exp_f32 v55, v55
    v_max_f32 v13, v15, v14
    v_cvt_pk_bf16_f32 v76, v48, v49
    v_cvt_pk_bf16_f32 v77, v50, v51
    v_cvt_pk_bf16_f32 v78, v52, v53
    v_cvt_pk_bf16_f32 v79, v54, v55
    v_cmp_lt_f32 vcc, s40, v13
    s_nop 0
    v_mfma_f32_32x32x16_bf16 v[80:95], v[108:111], v[76:79], v[80:95]
    ds_read_b128 v[104:107], v126 offset:5248
    ds_read_b128 v[108:111], v126 offset:5920
    s_cbranch_vccz k2_f_20
    v_mov_b32 v14, v13
    s_nop 1
    v_permlane32_swap_b32 v14, v13
    v_max_f32 v13, v13, v14
    v_max_f32 v14, 0, v13
    v_add_f32 v12, v12, v14
    v_sub_f32 v15, 0, v14
    v_exp_f32 v15, v15
    v_sub_f32 v56, v56, v14
    v_sub_f32 v24, v24, v14
    v_mul_f32 v80, v80, v15
    v_sub_f32 v57, v57, v14
    v_sub_f32 v25, v25, v14
    v_mul_f32 v81, v81, v15
    v_sub_f32 v58, v58, v14
    v_sub_f32 v26, v26, v14
    v_mul_f32 v82, v82, v15
    v_sub_f32 v59, v59, v14
    v_sub_f32 v27, v27, v14
    v_mul_f32 v83, v83, v15
    v_sub_f32 v60, v60, v14
    v_sub_f32 v28, v28, v14
    v_mul_f32 v84, v84, v15
    v_sub_f32 v61, v61, v14
    v_sub_f32 v29, v29, v14
    v_mul_f32 v85, v85, v15
    v_sub_f32 v62, v62, v14
    v_sub_f32 v30, v30, v14
    v_mul_f32 v86, v86, v15
    v_sub_f32 v63, v63, v14
    v_sub_f32 v31, v31, v14
    v_mul_f32 v87, v87, v15
    v_sub_f32 v64, v64, v14
    v_sub_f32 v32, v32, v14
    v_mul_f32 v88, v88, v15
    v_sub_f32 v65, v65, v14
    v_sub_f32 v33, v33, v14
    v_mul_f32 v89, v89, v15
    v_sub_f32 v66, v66, v14
    v_sub_f32 v34, v34, v14
    v_mul_f32 v90, v90, v15
    v_sub_f32 v67, v67, v14
    v_sub_f32 v35, v35, v14
    v_mul_f32 v91, v91, v15
    v_sub_f32 v68, v68, v14
    v_sub_f32 v36, v36, v14
    v_mul_f32 v92, v92, v15
    v_sub_f32 v69, v69, v14
    v_sub_f32 v37, v37, v14
    v_mul_f32 v93, v93, v15
    v_sub_f32 v70, v70, v14
    v_sub_f32 v38, v38, v14
    v_mul_f32 v94, v94, v15
    v_sub_f32 v71, v71, v14
    v_sub_f32 v39, v39, v14
    v_mul_f32 v95, v95, v15
    s_nop 1
k2_f_20:
    s_waitcnt lgkmcnt(2)
    v_mfma_f32_32x32x16_bf16 v[40:55], v[96:99], v[16:19], v[24:39]
    v_exp_f32 v56, v56
    v_exp_f32 v57, v57
    v_exp_f32 v58, v58
    v_exp_f32 v59, v59
    v_mfma_f32_32x32x16_bf16 v[40:55], v[100:103], v[20:23], v[40:55]
    ds_read_b128 v[96:99], v124 offset:15744
    ds_read_b32 v100, v125 offset:15744
    v_exp_f32 v60, v60
    v_exp_f32 v61, v61
    v_exp_f32 v62, v62
    v_exp_f32 v63, v63
    v_cvt_pk_bf16_f32 v72, v56, v57
    v_cvt_pk_bf16_f32 v73, v58, v59
    v_cvt_pk_bf16_f32 v74, v60, v61
    v_cvt_pk_bf16_f32 v75, v62, v63
    s_waitcnt lgkmcnt(2)
    s_nop 0
    v_mfma_f32_32x32x16_bf16 v[80:95], v[104:107], v[72:75], v[80:95]
    v_exp_f32 v64, v64
    v_max3_f32 v13, v40, v41, v42
    v_exp_f32 v65, v65
    v_max3_f32 v14, v43, v44, v45
    v_exp_f32 v66, v66
    v_max3_f32 v15, v46, v47, v48
    v_exp_f32 v67, v67
    v_max3_f32 v1, v49, v50, v51
    v_exp_f32 v68, v68
    v_max3_f32 v13, v13, v52, v53
    v_exp_f32 v69, v69
    v_max3_f32 v14, v14, v54, v55
    v_exp_f32 v70, v70
    v_max3_f32 v15, v15, v1, v13
    v_exp_f32 v71, v71
    v_max_f32 v13, v15, v14
    v_cvt_pk_bf16_f32 v76, v64, v65
    v_cvt_pk_bf16_f32 v77, v66, v67
    v_cvt_pk_bf16_f32 v78, v68, v69
    v_cvt_pk_bf16_f32 v79, v70, v71
    v_cmp_lt_f32 vcc, s40, v13
    s_nop 0
    v_mfma_f32_32x32x16_bf16 v[80:95], v[108:111], v[76:79], v[80:95]
    ds_read_b128 v[104:107], v126 offset:10496
    ds_read_b128 v[108:111], v126 offset:11168
    s_cbranch_vccz k2_f_21
    v_mov_b32 v14, v13
    s_nop 1
    v_permlane32_swap_b32 v14, v13
    v_max_f32 v13, v13, v14
    v_max_f32 v14, 0, v13
    v_add_f32 v12, v12, v14
    v_sub_f32 v15, 0, v14
    v_exp_f32 v15, v15
    v_sub_f32 v40, v40, v14
    v_sub_f32 v24, v24, v14
    v_mul_f32 v80, v80, v15
    v_sub_f32 v41, v41, v14
    v_sub_f32 v25, v25, v14
    v_mul_f32 v81, v81, v15
    v_sub_f32 v42, v42, v14
    v_sub_f32 v26, v26, v14
    v_mul_f32 v82, v82, v15
    v_sub_f32 v43, v43, v14
    v_sub_f32 v27, v27, v14
    v_mul_f32 v83, v83, v15
    v_sub_f32 v44, v44, v14
    v_sub_f32 v28, v28, v14
    v_mul_f32 v84, v84, v15
    v_sub_f32 v45, v45, v14
    v_sub_f32 v29, v29, v14
    v_mul_f32 v85, v85, v15
    v_sub_f32 v46, v46, v14
    v_sub_f32 v30, v30, v14
    v_mul_f32 v86, v86, v15
    v_sub_f32 v47, v47, v14
    v_sub_f32 v31, v31, v14
    v_mul_f32 v87, v87, v15
    v_sub_f32 v48, v48, v14
    v_sub_f32 v32, v32, v14
    v_mul_f32 v88, v88, v15
    v_sub_f32 v49, v49, v14
    v_sub_f32 v33, v33, v14
    v_mul_f32 v89, v89, v15
    v_sub_f32 v50, v50, v14
    v_sub_f32 v34, v34, v14
    v_mul_f32 v90, v90, v15
    v_sub_f32 v51, v51, v14
    v_sub_f32 v35, v35, v14
    v_mul_f32 v91, v91, v15
    v_sub_f32 v52, v52, v14
    v_sub_f32 v36, v36, v14
    v_mul_f32 v92, v92, v15
    v_sub_f32 v53, v53, v14
    v_sub_f32 v37, v37, v14
    v_mul_f32 v93, v93, v15
    v_sub_f32 v54, v54, v14
    v_sub_f32 v38, v38, v14
    v_mul_f32 v94, v94, v15
    v_sub_f32 v55, v55, v14
    v_sub_f32 v39, v39, v14
    v_mul_f32 v95, v95, v15
    s_nop 1
k2_f_21:
    s_waitcnt lgkmcnt(2)
    v_mfma_f32_32x32x16_bf16 v[56:71], v[96:99], v[16:19], v[24:39]
    v_exp_f32 v40, v40
    v_exp_f32 v41, v41
    v_exp_f32 v42, v42
    v_exp_f32 v43, v43
    v_mfma_f32_32x32x16_bf16 v[56:71], v[100:103], v[20:23], v[56:71]
    ds_read_b128 v[96:99], v124 offset:20992
    ds_read_b32 v100, v125 offset:20992
    v_exp_f32 v44, v44
    v_exp_f32 v45, v45
    v_exp_f32 v46, v46
    v_exp_f32 v47, v47
    v_cvt_pk_bf16_f32 v72, v40, v41
    v_cvt_pk_bf16_f32 v73, v42, v43
    v_cvt_pk_bf16_f32 v74, v44, v45
    v_cvt_pk_bf16_f32 v75, v46, v47
    s_waitcnt lgkmcnt(2)
    s_nop 0
    v_mfma_f32_32x32x16_bf16 v[80:95], v[104:107], v[72:75], v[80:95]
    v_exp_f32 v48, v48
    v_max3_f32 v13, v56, v57, v58
    v_exp_f32 v49, v49
    v_max3_f32 v14, v59, v60, v61
    v_exp_f32 v50, v50
    v_max3_f32 v15, v62, v63, v64
    v_exp_f32 v51, v51
    v_max3_f32 v1, v65, v66, v67
    v_exp_f32 v52, v52
    v_max3_f32 v13, v13, v68, v69
    v_exp_f32 v53, v53
    v_max3_f32 v14, v14, v70, v71
    v_exp_f32 v54, v54
    v_max3_f32 v15, v15, v1, v13
    v_exp_f32 v55, v55
    v_max_f32 v13, v15, v14
    v_cvt_pk_bf16_f32 v76, v48, v49
    v_cvt_pk_bf16_f32 v77, v50, v51
    v_cvt_pk_bf16_f32 v78, v52, v53
    v_cvt_pk_bf16_f32 v79, v54, v55
    v_cmp_lt_f32 vcc, s40, v13
    s_nop 0
    v_mfma_f32_32x32x16_bf16 v[80:95], v[108:111], v[76:79], v[80:95]
    ds_read_b128 v[104:107], v126 offset:15744
    ds_read_b128 v[108:111], v126 offset:16416
    s_cbranch_vccz k2_f_22
    v_mov_b32 v14, v13
    s_nop 1
    v_permlane32_swap_b32 v14, v13
    v_max_f32 v13, v13, v14
    v_max_f32 v14, 0, v13
    v_add_f32 v12, v12, v14
    v_sub_f32 v15, 0, v14
    v_exp_f32 v15, v15
    v_sub_f32 v56, v56, v14
    v_sub_f32 v24, v24, v14
    v_mul_f32 v80, v80, v15
    v_sub_f32 v57, v57, v14
    v_sub_f32 v25, v25, v14
    v_mul_f32 v81, v81, v15
    v_sub_f32 v58, v58, v14
    v_sub_f32 v26, v26, v14
    v_mul_f32 v82, v82, v15
    v_sub_f32 v59, v59, v14
    v_sub_f32 v27, v27, v14
    v_mul_f32 v83, v83, v15
    v_sub_f32 v60, v60, v14
    v_sub_f32 v28, v28, v14
    v_mul_f32 v84, v84, v15
    v_sub_f32 v61, v61, v14
    v_sub_f32 v29, v29, v14
    v_mul_f32 v85, v85, v15
    v_sub_f32 v62, v62, v14
    v_sub_f32 v30, v30, v14
    v_mul_f32 v86, v86, v15
    v_sub_f32 v63, v63, v14
    v_sub_f32 v31, v31, v14
    v_mul_f32 v87, v87, v15
    v_sub_f32 v64, v64, v14
    v_sub_f32 v32, v32, v14
    v_mul_f32 v88, v88, v15
    v_sub_f32 v65, v65, v14
    v_sub_f32 v33, v33, v14
    v_mul_f32 v89, v89, v15
    v_sub_f32 v66, v66, v14
    v_sub_f32 v34, v34, v14
    v_mul_f32 v90, v90, v15
    v_sub_f32 v67, v67, v14
    v_sub_f32 v35, v35, v14
    v_mul_f32 v91, v91, v15
    v_sub_f32 v68, v68, v14
    v_sub_f32 v36, v36, v14
    v_mul_f32 v92, v92, v15
    v_sub_f32 v69, v69, v14
    v_sub_f32 v37, v37, v14
    v_mul_f32 v93, v93, v15
    v_sub_f32 v70, v70, v14
    v_sub_f32 v38, v38, v14
    v_mul_f32 v94, v94, v15
    v_sub_f32 v71, v71, v14
    v_sub_f32 v39, v39, v14
    v_mul_f32 v95, v95, v15
    s_nop 1
k2_f_22:
    s_waitcnt lgkmcnt(2)
    v_mfma_f32_32x32x16_bf16 v[40:55], v[96:99], v[16:19], v[24:39]
    v_exp_f32 v56, v56
    v_exp_f32 v57, v57
    v_exp_f32 v58, v58
    v_exp_f32 v59, v59
    v_mfma_f32_32x32x16_bf16 v[40:55], v[100:103], v[20:23], v[40:55]
    ds_read_b128 v[96:99], v124 offset:26240
    ds_read_b32 v100, v125 offset:26240
    v_exp_f32 v60, v60
    v_exp_f32 v61, v61
    v_exp_f32 v62, v62
    v_exp_f32 v63, v63
    v_cvt_pk_bf16_f32 v72, v56, v57
    v_cvt_pk_bf16_f32 v73, v58, v59
    v_cvt_pk_bf16_f32 v74, v60, v61
    v_cvt_pk_bf16_f32 v75, v62, v63
    s_waitcnt lgkmcnt(2)
    s_nop 0
    v_mfma_f32_32x32x16_bf16 v[80:95], v[104:107], v[72:75], v[80:95]
    v_exp_f32 v64, v64
    v_max3_f32 v13, v40, v41, v42
    v_exp_f32 v65, v65
    v_max3_f32 v14, v43, v44, v45
    v_exp_f32 v66, v66
    v_max3_f32 v15, v46, v47, v48
    v_exp_f32 v67, v67
    v_max3_f32 v1, v49, v50, v51
    v_exp_f32 v68, v68
    v_max3_f32 v13, v13, v52, v53
    v_exp_f32 v69, v69
    v_max3_f32 v14, v14, v54, v55
    v_exp_f32 v70, v70
    v_max3_f32 v15, v15, v1, v13
    v_exp_f32 v71, v71
    v_max_f32 v13, v15, v14
    v_cvt_pk_bf16_f32 v76, v64, v65
    v_cvt_pk_bf16_f32 v77, v66, v67
    v_cvt_pk_bf16_f32 v78, v68, v69
    v_cvt_pk_bf16_f32 v79, v70, v71
    v_cmp_lt_f32 vcc, s40, v13
    s_nop 0
    v_mfma_f32_32x32x16_bf16 v[80:95], v[108:111], v[76:79], v[80:95]
    ds_read_b128 v[104:107], v126 offset:20992
    ds_read_b128 v[108:111], v126 offset:21664
    s_cbranch_vccz k2_f_23
    v_mov_b32 v14, v13
    s_nop 1
    v_permlane32_swap_b32 v14, v13
    v_max_f32 v13, v13, v14
    v_max_f32 v14, 0, v13
    v_add_f32 v12, v12, v14
    v_sub_f32 v15, 0, v14
    v_exp_f32 v15, v15
    v_sub_f32 v40, v40, v14
    v_sub_f32 v24, v24, v14
    v_mul_f32 v80, v80, v15
    v_sub_f32 v41, v41, v14
    v_sub_f32 v25, v25, v14
    v_mul_f32 v81, v81, v15
    v_sub_f32 v42, v42, v14
    v_sub_f32 v26, v26, v14
    v_mul_f32 v82, v82, v15
    v_sub_f32 v43, v43, v14
    v_sub_f32 v27, v27, v14
    v_mul_f32 v83, v83, v15
    v_sub_f32 v44, v44, v14
    v_sub_f32 v28, v28, v14
    v_mul_f32 v84, v84, v15
    v_sub_f32 v45, v45, v14
    v_sub_f32 v29, v29, v14
    v_mul_f32 v85, v85, v15
    v_sub_f32 v46, v46, v14
    v_sub_f32 v30, v30, v14
    v_mul_f32 v86, v86, v15
    v_sub_f32 v47, v47, v14
    v_sub_f32 v31, v31, v14
    v_mul_f32 v87, v87, v15
    v_sub_f32 v48, v48, v14
    v_sub_f32 v32, v32, v14
    v_mul_f32 v88, v88, v15
    v_sub_f32 v49, v49, v14
    v_sub_f32 v33, v33, v14
    v_mul_f32 v89, v89, v15
    v_sub_f32 v50, v50, v14
    v_sub_f32 v34, v34, v14
    v_mul_f32 v90, v90, v15
    v_sub_f32 v51, v51, v14
    v_sub_f32 v35, v35, v14
    v_mul_f32 v91, v91, v15
    v_sub_f32 v52, v52, v14
    v_sub_f32 v36, v36, v14
    v_mul_f32 v92, v92, v15
    v_sub_f32 v53, v53, v14
    v_sub_f32 v37, v37, v14
    v_mul_f32 v93, v93, v15
    v_sub_f32 v54, v54, v14
    v_sub_f32 v38, v38, v14
    v_mul_f32 v94, v94, v15
    v_sub_f32 v55, v55, v14
    v_sub_f32 v39, v39, v14
    v_mul_f32 v95, v95, v15
    s_nop 1
k2_f_23:
    s_waitcnt vmcnt(0)
    ds_write_b128 v127, v[112:115] offset:0
    ds_write_b128 v127, v[116:119] offset:16384
    ds_write_b128 v127, v[120:123] offset:32768
    s_waitcnt lgkmcnt(5)
    v_mfma_f32_32x32x16_bf16 v[56:71], v[96:99], v[16:19], v[24:39]
    v_exp_f32 v40, v40
    v_exp_f32 v41, v41
    v_exp_f32 v42, v42
    v_exp_f32 v43, v43
    v_mfma_f32_32x32x16_bf16 v[56:71], v[100:103], v[20:23], v[56:71]
    ds_read_b128 v[96:99], v124 offset:31488
    ds_read_b32 v100, v125 offset:31488
    v_exp_f32 v44, v44
    v_exp_f32 v45, v45
    v_exp_f32 v46, v46
    v_exp_f32 v47, v47
    v_cvt_pk_bf16_f32 v72, v40, v41
    v_cvt_pk_bf16_f32 v73, v42, v43
    v_cvt_pk_bf16_f32 v74, v44, v45
    v_cvt_pk_bf16_f32 v75, v46, v47
    s_waitcnt lgkmcnt(5)
    s_nop 0
    v_mfma_f32_32x32x16_bf16 v[80:95], v[104:107], v[72:75], v[80:95]
    v_exp_f32 v48, v48
    v_max3_f32 v13, v56, v57, v58
    v_exp_f32 v49, v49
    v_max3_f32 v14, v59, v60, v61
    v_exp_f32 v50, v50
    v_max3_f32 v15, v62, v63, v64
    v_exp_f32 v51, v51
    v_max3_f32 v1, v65, v66, v67
    v_exp_f32 v52, v52
    v_max3_f32 v13, v13, v68, v69
    v_exp_f32 v53, v53
    v_max3_f32 v14, v14, v70, v71
    v_exp_f32 v54, v54
    v_max3_f32 v15, v15, v1, v13
    v_exp_f32 v55, v55
    v_max_f32 v13, v15, v14
    v_cvt_pk_bf16_f32 v76, v48, v49
    v_cvt_pk_bf16_f32 v77, v50, v51
    v_cvt_pk_bf16_f32 v78, v52, v53
    v_cvt_pk_bf16_f32 v79, v54, v55
    v_cmp_lt_f32 vcc, s40, v13
    s_nop 0
    v_mfma_f32_32x32x16_bf16 v[80:95], v[108:111], v[76:79], v[80:95]
    ds_read_b128 v[104:107], v126 offset:26240
    ds_read_b128 v[108:111], v126 offset:26912
    s_cbranch_vccz k2_f_24
    v_mov_b32 v14, v13
    s_nop 1
    v_permlane32_swap_b32 v14, v13
    v_max_f32 v13, v13, v14
    v_max_f32 v14, 0, v13
    v_add_f32 v12, v12, v14
    v_sub_f32 v15, 0, v14
    v_exp_f32 v15, v15
    v_sub_f32 v56, v56, v14
    v_sub_f32 v24, v24, v14
    v_mul_f32 v80, v80, v15
    v_sub_f32 v57, v57, v14
    v_sub_f32 v25, v25, v14
    v_mul_f32 v81, v81, v15
    v_sub_f32 v58, v58, v14
    v_sub_f32 v26, v26, v14
    v_mul_f32 v82, v82, v15
    v_sub_f32 v59, v59, v14
    v_sub_f32 v27, v27, v14
    v_mul_f32 v83, v83, v15
    v_sub_f32 v60, v60, v14
    v_sub_f32 v28, v28, v14
    v_mul_f32 v84, v84, v15
    v_sub_f32 v61, v61, v14
    v_sub_f32 v29, v29, v14
    v_mul_f32 v85, v85, v15
    v_sub_f32 v62, v62, v14
    v_sub_f32 v30, v30, v14
    v_mul_f32 v86, v86, v15
    v_sub_f32 v63, v63, v14
    v_sub_f32 v31, v31, v14
    v_mul_f32 v87, v87, v15
    v_sub_f32 v64, v64, v14
    v_sub_f32 v32, v32, v14
    v_mul_f32 v88, v88, v15
    v_sub_f32 v65, v65, v14
    v_sub_f32 v33, v33, v14
    v_mul_f32 v89, v89, v15
    v_sub_f32 v66, v66, v14
    v_sub_f32 v34, v34, v14
    v_mul_f32 v90, v90, v15
    v_sub_f32 v67, v67, v14
    v_sub_f32 v35, v35, v14
    v_mul_f32 v91, v91, v15
    v_sub_f32 v68, v68, v14
    v_sub_f32 v36, v36, v14
    v_mul_f32 v92, v92, v15
    v_sub_f32 v69, v69, v14
    v_sub_f32 v37, v37, v14
    v_mul_f32 v93, v93, v15
    v_sub_f32 v70, v70, v14
    v_sub_f32 v38, v38, v14
    v_mul_f32 v94, v94, v15
    v_sub_f32 v71, v71, v14
    v_sub_f32 v39, v39, v14
    v_mul_f32 v95, v95, v15
    s_nop 1
k2_f_24:
    s_waitcnt lgkmcnt(2)
    v_mfma_f32_32x32x16_bf16 v[40:55], v[96:99], v[16:19], v[24:39]
    v_exp_f32 v56, v56
    v_exp_f32 v57, v57
    v_exp_f32 v58, v58
    v_exp_f32 v59, v59
    v_mfma_f32_32x32x16_bf16 v[40:55], v[100:103], v[20:23], v[40:55]
    ds_read_b128 v[96:99], v124 offset:36736
    ds_read_b32 v100, v125 offset:36736
    v_exp_f32 v60, v60
    v_exp_f32 v61, v61
    v_exp_f32 v62, v62
    v_exp_f32 v63, v63
    v_cvt_pk_bf16_f32 v72, v56, v57
    v_cvt_pk_bf16_f32 v73, v58, v59
    v_cvt_pk_bf16_f32 v74, v60, v61
    v_cvt_pk_bf16_f32 v75, v62, v63
    s_waitcnt lgkmcnt(2)
    s_nop 0
    v_mfma_f32_32x32x16_bf16 v[80:95], v[104:107], v[72:75], v[80:95]
    v_exp_f32 v64, v64
    v_max3_f32 v13, v40, v41, v42
    v_exp_f32 v65, v65
    v_max3_f32 v14, v43, v44, v45
    v_exp_f32 v66, v66
    v_max3_f32 v15, v46, v47, v48
    v_exp_f32 v67, v67
    v_max3_f32 v1, v49, v50, v51
    v_exp_f32 v68, v68
    v_max3_f32 v13, v13, v52, v53
    v_exp_f32 v69, v69
    v_max3_f32 v14, v14, v54, v55
    v_exp_f32 v70, v70
    v_max3_f32 v15, v15, v1, v13
    v_exp_f32 v71, v71
    v_max_f32 v13, v15, v14
    v_cvt_pk_bf16_f32 v76, v64, v65
    v_cvt_pk_bf16_f32 v77, v66, v67
    v_cvt_pk_bf16_f32 v78, v68, v69
    v_cvt_pk_bf16_f32 v79, v70, v71
    v_cmp_lt_f32 vcc, s40, v13
    s_nop 0
    v_mfma_f32_32x32x16_bf16 v[80:95], v[108:111], v[76:79], v[80:95]
    ds_read_b128 v[104:107], v126 offset:31488
    ds_read_b128 v[108:111], v126 offset:32160
    s_cbranch_vccz k2_f_25
    v_mov_b32 v14, v13
    s_nop 1
    v_permlane32_swap_b32 v14, v13
    v_max_f32 v13, v13, v14
    v_max_f32 v14, 0, v13
    v_add_f32 v12, v12, v14
    v_sub_f32 v15, 0, v14
    v_exp_f32 v15, v15
    v_sub_f32 v40, v40, v14
    v_sub_f32 v24, v24, v14
    v_mul_f32 v80, v80, v15
    v_sub_f32 v41, v41, v14
    v_sub_f32 v25, v25, v14
    v_mul_f32 v81, v81, v15
    v_sub_f32 v42, v42, v14
    v_sub_f32 v26, v26, v14
    v_mul_f32 v82, v82, v15
    v_sub_f32 v43, v43, v14
    v_sub_f32 v27, v27, v14
    v_mul_f32 v83, v83, v15
    v_sub_f32 v44, v44, v14
    v_sub_f32 v28, v28, v14
    v_mul_f32 v84, v84, v15
    v_sub_f32 v45, v45, v14
    v_sub_f32 v29, v29, v14
    v_mul_f32 v85, v85, v15
    v_sub_f32 v46, v46, v14
    v_sub_f32 v30, v30, v14
    v_mul_f32 v86, v86, v15
    v_sub_f32 v47, v47, v14
    v_sub_f32 v31, v31, v14
    v_mul_f32 v87, v87, v15
    v_sub_f32 v48, v48, v14
    v_sub_f32 v32, v32, v14
    v_mul_f32 v88, v88, v15
    v_sub_f32 v49, v49, v14
    v_sub_f32 v33, v33, v14
    v_mul_f32 v89, v89, v15
    v_sub_f32 v50, v50, v14
    v_sub_f32 v34, v34, v14
    v_mul_f32 v90, v90, v15
    v_sub_f32 v51, v51, v14
    v_sub_f32 v35, v35, v14
    v_mul_f32 v91, v91, v15
    v_sub_f32 v52, v52, v14
    v_sub_f32 v36, v36, v14
    v_mul_f32 v92, v92, v15
    v_sub_f32 v53, v53, v14
    v_sub_f32 v37, v37, v14
    v_mul_f32 v93, v93, v15
    v_sub_f32 v54, v54, v14
    v_sub_f32 v38, v38, v14
    v_mul_f32 v94, v94, v15
    v_sub_f32 v55, v55, v14
    v_sub_f32 v39, v39, v14
    v_mul_f32 v95, v95, v15
    s_nop 1
k2_f_25:
    s_waitcnt lgkmcnt(2)
    v_mfma_f32_32x32x16_bf16 v[56:71], v[96:99], v[16:19], v[24:39]
    v_exp_f32 v40, v40
    v_exp_f32 v41, v41
    v_exp_f32 v42, v42
    v_exp_f32 v43, v43
    v_mfma_f32_32x32x16_bf16 v[56:71], v[100:103], v[20:23], v[56:71]
    v_exp_f32 v44, v44
    v_exp_f32 v45, v45
    v_exp_f32 v46, v46
    v_exp_f32 v47, v47
    v_cvt_pk_bf16_f32 v72, v40, v41
    v_cvt_pk_bf16_f32 v73, v42, v43
    v_cvt_pk_bf16_f32 v74, v44, v45
    v_cvt_pk_bf16_f32 v75, v46, v47
    s_waitcnt lgkmcnt(0)
    s_nop 0
    v_mfma_f32_32x32x16_bf16 v[80:95], v[104:107], v[72:75], v[80:95]
    v_exp_f32 v48, v48
    v_max3_f32 v13, v56, v57, v58
    v_exp_f32 v49, v49
    v_max3_f32 v14, v59, v60, v61
    v_exp_f32 v50, v50
    v_max3_f32 v15, v62, v63, v64
    v_exp_f32 v51, v51
    v_max3_f32 v1, v65, v66, v67
    v_exp_f32 v52, v52
    v_max3_f32 v13, v13, v68, v69
    v_exp_f32 v53, v53
    v_max3_f32 v14, v14, v70, v71
    v_exp_f32 v54, v54
    v_max3_f32 v15, v15, v1, v13
    v_exp_f32 v55, v55
    v_max_f32 v13, v15, v14
    v_cvt_pk_bf16_f32 v76, v48, v49
    v_cvt_pk_bf16_f32 v77, v50, v51
    v_cvt_pk_bf16_f32 v78, v52, v53
    v_cvt_pk_bf16_f32 v79, v54, v55
    v_cmp_lt_f32 vcc, s40, v13
    s_nop 0
    v_mfma_f32_32x32x16_bf16 v[80:95], v[108:111], v[76:79], v[80:95]
    ds_read_b128 v[104:107], v126 offset:36736
    ds_read_b128 v[108:111], v126 offset:37408
    s_cbranch_vccz k2_f_26
    v_mov_b32 v14, v13
    s_nop 1
    v_permlane32_swap_b32 v14, v13
    v_max_f32 v13, v13, v14
    v_max_f32 v14, 0, v13
    v_add_f32 v12, v12, v14
    v_sub_f32 v15, 0, v14
    v_exp_f32 v15, v15
    v_sub_f32 v56, v56, v14
    v_sub_f32 v24, v24, v14
    v_mul_f32 v80, v80, v15
    v_sub_f32 v57, v57, v14
    v_sub_f32 v25, v25, v14
    v_mul_f32 v81, v81, v15
    v_sub_f32 v58, v58, v14
    v_sub_f32 v26, v26, v14
    v_mul_f32 v82, v82, v15
    v_sub_f32 v59, v59, v14
    v_sub_f32 v27, v27, v14
    v_mul_f32 v83, v83, v15
    v_sub_f32 v60, v60, v14
    v_sub_f32 v28, v28, v14
    v_mul_f32 v84, v84, v15
    v_sub_f32 v61, v61, v14
    v_sub_f32 v29, v29, v14
    v_mul_f32 v85, v85, v15
    v_sub_f32 v62, v62, v14
    v_sub_f32 v30, v30, v14
    v_mul_f32 v86, v86, v15
    v_sub_f32 v63, v63, v14
    v_sub_f32 v31, v31, v14
    v_mul_f32 v87, v87, v15
    v_sub_f32 v64, v64, v14
    v_sub_f32 v32, v32, v14
    v_mul_f32 v88, v88, v15
    v_sub_f32 v65, v65, v14
    v_sub_f32 v33, v33, v14
    v_mul_f32 v89, v89, v15
    v_sub_f32 v66, v66, v14
    v_sub_f32 v34, v34, v14
    v_mul_f32 v90, v90, v15
    v_sub_f32 v67, v67, v14
    v_sub_f32 v35, v35, v14
    v_mul_f32 v91, v91, v15
    v_sub_f32 v68, v68, v14
    v_sub_f32 v36, v36, v14
    v_mul_f32 v92, v92, v15
    v_sub_f32 v69, v69, v14
    v_sub_f32 v37, v37, v14
    v_mul_f32 v93, v93, v15
    v_sub_f32 v70, v70, v14
    v_sub_f32 v38, v38, v14
    v_mul_f32 v94, v94, v15
    v_sub_f32 v71, v71, v14
    v_sub_f32 v39, v39, v14
    v_mul_f32 v95, v95, v15
    s_nop 1
k2_f_26:
    v_exp_f32 v56, v56
    v_exp_f32 v57, v57
    v_exp_f32 v58, v58
    v_exp_f32 v59, v59
    v_exp_f32 v60, v60
    v_exp_f32 v61, v61
    v_exp_f32 v62, v62
    v_exp_f32 v63, v63
    v_cvt_pk_bf16_f32 v72, v56, v57
    v_cvt_pk_bf16_f32 v73, v58, v59
    v_cvt_pk_bf16_f32 v74, v60, v61
    v_cvt_pk_bf16_f32 v75, v62, v63
    s_waitcnt lgkmcnt(0)
    s_nop 0
    v_mfma_f32_32x32x16_bf16 v[80:95], v[104:107], v[72:75], v[80:95]
    v_exp_f32 v64, v64
    v_exp_f32 v65, v65
    v_exp_f32 v66, v66
    v_exp_f32 v67, v67
    v_exp_f32 v68, v68
    v_exp_f32 v69, v69
    v_exp_f32 v70, v70
    v_exp_f32 v71, v71
    v_cvt_pk_bf16_f32 v76, v64, v65
    v_cvt_pk_bf16_f32 v77, v66, v67
    v_cvt_pk_bf16_f32 v78, v68, v69
    v_cvt_pk_bf16_f32 v79, v70, v71
    s_nop 1
    v_mfma_f32_32x32x16_bf16 v[80:95], v[108:111], v[76:79], v[80:95]
    s_mul_i32 s46, s24, 81920
    s_mul_i32 s47, s28, 1280
    s_add_u32 s46, s46, s47
    s_add_u32 s46, s46, 15728640
    buffer_load_dwordx4 v[16:19], v5, s[20:23], s46 offen
    v_subrev_u32 v1, 1024, v6
    buffer_load_dword v20, v1, s[20:23], s46 offen offset:1024
    s_barrier
    s_and_b32 s44, s27, 7
    s_mul_i32 s44, s44, 3328
    s_add_u32 s44, s44, 0
    v_lshlrev_b32 v14, 2, v2
    v_add_u32 v14, s44, v14
    s_cmp_eq_u32 s33, 0
    s_nop 0
    s_cbranch_scc1 k2_g0_a
    ds_write_b32 v14, v80 offset:0
    ds_write_b32 v14, v81 offset:256
    ds_write_b32 v14, v82 offset:512
    ds_write_b32 v14, v83 offset:768
    ds_write_b32 v14, v84 offset:1024
    ds_write_b32 v14, v85 offset:1280
    ds_write_b32 v14, v86 offset:1536
    ds_write_b32 v14, v87 offset:1792
    ds_write_b32 v14, v88 offset:2048
    ds_write_b32 v14, v89 offset:2304
    ds_write_b32 v14, v90 offset:2560
    ds_write_b32 v14, v91 offset:2816
    ds_write_b32 v14, v12 offset:3072
    s_waitcnt lgkmcnt(0)
    s_barrier
    s_branch k2_md_a
k2_g0_a:
    s_barrier
    ds_read_b32 v40, v14 offset:0
    ds_read_b32 v41, v14 offset:256
    ds_read_b32 v42, v14 offset:512
    ds_read_b32 v43, v14 offset:768
    ds_read_b32 v44, v14 offset:1024
    ds_read_b32 v45, v14 offset:1280
    ds_read_b32 v46, v14 offset:1536
    ds_read_b32 v47, v14 offset:1792
    ds_read_b32 v48, v14 offset:2048
    ds_read_b32 v49, v14 offset:2304
    ds_read_b32 v50, v14 offset:2560
    ds_read_b32 v51, v14 offset:2816
    ds_read_b32 v52, v14 offset:3072
    s_waitcnt lgkmcnt(0)
    v_max_f32 v15, v12, v52
    v_sub_f32 v13, v12, v15
    v_sub_f32 v1, v52, v15
    v_exp_f32 v13, v13
    v_exp_f32 v1, v1
    v_mul_f32 v80, v80, v13
    v_fmac_f32 v80, v40, v1
    v_mul_f32 v81, v81, v13
    v_fmac_f32 v81, v41, v1
    v_mul_f32 v82, v82, v13
    v_fmac_f32 v82, v42, v1
    v_mul_f32 v83, v83, v13
    v_fmac_f32 v83, v43, v1
    v_mul_f32 v84, v84, v13
    v_fmac_f32 v84, v44, v1
    v_mul_f32 v85, v85, v13
    v_fmac_f32 v85, v45, v1
    v_mul_f32 v86, v86, v13
    v_fmac_f32 v86, v46, v1
    v_mul_f32 v87, v87, v13
    v_fmac_f32 v87, v47, v1
    v_mul_f32 v88, v88, v13
    v_fmac_f32 v88, v48, v1
    v_mul_f32 v89, v89, v13
    v_fmac_f32 v89, v49, v1
    v_mul_f32 v90, v90, v13
    v_fmac_f32 v90, v50, v1
    v_mul_f32 v91, v91, v13
    v_fmac_f32 v91, v51, v1
    v_mov_b32 v14, v88
    v_mov_b32 v15, v88
    s_nop 1
    v_permlane32_swap_b32 v14, v15
    v_rcp_f32 v15, v15
    s_nop 0
    v_mul_f32 v80, v80, v15
    v_mul_f32 v81, v81, v15
    v_mul_f32 v82, v82, v15
    v_mul_f32 v83, v83, v15
    v_mul_f32 v84, v84, v15
    v_mul_f32 v85, v85, v15
    v_mul_f32 v86, v86, v15
    v_mul_f32 v87, v87, v15
    v_mul_f32 v88, v88, v15
    v_mul_f32 v89, v89, v15
    v_mul_f32 v90, v90, v15
    v_mul_f32 v91, v91, v15
    v_cvt_pk_bf16_f32 v72, v80, v81
    v_cvt_pk_bf16_f32 v73, v82, v83
    v_cvt_pk_bf16_f32 v74, v84, v85
    v_cvt_pk_bf16_f32 v75, v86, v87
    v_cvt_pk_bf16_f32 v76, v88, v89
    v_cvt_pk_bf16_f32 v77, v90, v91
    s_lshl_b32 s43, s28, 5
    v_add_u32 v14, s43, v3
    s_movk_i32 s44, 1280
    v_mul_lo_u32 v14, v14, s44
    v_lshl_add_u32 v14, v4, 3, v14
    s_mul_i32 s44, s24, 40
    s_add_u32 s44, s44, 18874368
    buffer_store_dwordx2 v[72:73], v14, s[20:23], s44 offen
    buffer_store_dwordx2 v[74:75], v14, s[20:23], s44 offen offset:16
    s_mov_b32 exec_hi, 0
    buffer_store_dwordx2 v[76:77], v14, s[20:23], s44 offen offset:32
    s_mov_b64 exec, -1
k2_md_a:
    v_lshlrev_b32 v10, 2, v4
    v_sub_u32 v10, v3, v10
    v_mov_b32 v11, 0xf149f2ca
    s_sub_u32 s44, s28, s35
    s_mul_i32 s45, s44, 2624
    s_add_u32 s45, s45, 49152
    v_add_u32 v124, s45, v5
    v_add_u32 v125, s45, v6
    v_add_u32 v126, s45, v7
    s_waitcnt vmcnt(0)
    s_cmp_lg_u32 s33, 0
    s_cbranch_scc1 k2_b1
    ds_read_b128 v[96:99], v124 offset:0
    ds_read_b32 v100, v125 offset:0
    ds_read_b128 v[104:107], v126 offset:0
    ds_read_b128 v[108:111], v126 offset:672
    s_waitcnt lgkmcnt(0)
    v_mfma_f32_32x32x16_bf16 v[40:55], v[96:99], v[16:19], 0
    v_mfma_f32_32x32x16_bf16 v[40:55], v[100:103], v[20:23], v[40:55]
    v_cmp_le_i32 vcc, 0, v10
    s_nop 10
    v_cndmask_b32 v40, v11, v40, vcc
    v_cmp_le_i32 vcc, 1, v10
    s_nop 1
    v_cndmask_b32 v41, v11, v41, vcc
    v_cmp_le_i32 vcc, 2, v10
    s_nop 1
    v_cndmask_b32 v42, v11, v42, vcc
    v_cmp_le_i32 vcc, 3, v10
    s_nop 1
    v_cndmask_b32 v43, v11, v43, vcc
    v_cmp_le_i32 vcc, 8, v10
    s_nop 1
    v_cndmask_b32 v44, v11, v44, vcc
    v_cmp_le_i32 vcc, 9, v10
    s_nop 1
    v_cndmask_b32 v45, v11, v45, vcc
    v_cmp_le_i32 vcc, 10, v10
    s_nop 1
    v_cndmask_b32 v46, v11, v46, vcc
    v_cmp_le_i32 vcc, 11, v10
    s_nop 1
    v_cndmask_b32 v47, v11, v47, vcc
    v_cmp_le_i32 vcc, 16, v10
    s_nop 1
    v_cndmask_b32 v48, v11, v48, vcc
    v_cmp_le_i32 vcc, 17, v10
    s_nop 1
    v_cndmask_b32 v49, v11, v49, vcc
    v_cmp_le_i32 vcc, 18, v10
    s_nop 1
    v_cndmask_b32 v50, v11, v50, vcc
    v_cmp_le_i32 vcc, 19, v10
    s_nop 1
    v_cndmask_b32 v51, v11, v51, vcc
    v_cmp_le_i32 vcc, 24, v10
    s_nop 1
    v_cndmask_b32 v52, v11, v52, vcc
    v_cmp_le_i32 vcc, 25, v10
    s_nop 1
    v_cndmask_b32 v53, v11, v53, vcc
    v_cmp_le_i32 vcc, 26, v10
    s_nop 1
    v_cndmask_b32 v54, v11, v54, vcc
    v_cmp_le_i32 vcc, 27, v10
    s_nop 1
    v_cndmask_b32 v55, v11, v55, vcc
    v_max3_f32 v13, v40, v41, v42
    v_max3_f32 v14, v43, v44, v45
    v_max3_f32 v15, v46, v47, v48
    v_max3_f32 v1, v49, v50, v51
    v_max3_f32 v13, v13, v52, v53
    v_max3_f32 v14, v14, v54, v55
    v_max3_f32 v15, v15, v1, v13
    v_max_f32 v13, v15, v14
    v_mov_b32 v14, v13
    s_nop 1
    v_permlane32_swap_b32 v14, v13
    v_max_f32 v13, v13, v14
    v_mov_b32 v12, v13
    v_sub_f32 v24, 0, v13
    v_mov_b32 v80, 0
    v_sub_f32 v25, 0, v13
    v_mov_b32 v81, 0
    v_sub_f32 v26, 0, v13
    v_mov_b32 v82, 0
    v_sub_f32 v27, 0, v13
    v_mov_b32 v83, 0
    v_sub_f32 v28, 0, v13
    v_mov_b32 v84, 0
    v_sub_f32 v29, 0, v13
    v_mov_b32 v85, 0
    v_sub_f32 v30, 0, v13
    v_mov_b32 v86, 0
    v_sub_f32 v31, 0, v13
    v_mov_b32 v87, 0
    v_sub_f32 v32, 0, v13
    v_mov_b32 v88, 0
    v_sub_f32 v33, 0, v13
    v_mov_b32 v89, 0
    v_sub_f32 v34, 0, v13
    v_mov_b32 v90, 0
    v_sub_f32 v35, 0, v13
    v_mov_b32 v91, 0
    v_sub_f32 v36, 0, v13
    v_mov_b32 v92, 0
    v_sub_f32 v37, 0, v13
    v_mov_b32 v93, 0
    v_sub_f32 v38, 0, v13
    v_mov_b32 v94, 0
    v_sub_f32 v39, 0, v13
    v_mov_b32 v95, 0
    s_nop 0
    v_mfma_f32_32x32x16_bf16 v[40:55], v[96:99], v[16:19], v[24:39]
    v_mfma_f32_32x32x16_bf16 v[40:55], v[100:103], v[20:23], v[40:55]
    v_cmp_le_i32 vcc, 0, v10
    s_nop 10
    v_cndmask_b32 v40, v11, v40, vcc
    v_cmp_le_i32 vcc, 1, v10
    s_nop 1
    v_cndmask_b32 v41, v11, v41, vcc
    v_cmp_le_i32 vcc, 2, v10
    s_nop 1
    v_cndmask_b32 v42, v11, v42, vcc
    v_cmp_le_i32 vcc, 3, v10
    s_nop 1
    v_cndmask_b32 v43, v11, v43, vcc
    v_cmp_le_i32 vcc, 8, v10
    s_nop 1
    v_cndmask_b32 v44, v11, v44, vcc
    v_cmp_le_i32 vcc, 9, v10
    s_nop 1
    v_cndmask_b32 v45, v11, v45, vcc
    v_cmp_le_i32 vcc, 10, v10
    s_nop 1
    v_cndmask_b32 v46, v11, v46, vcc
    v_cmp_le_i32 vcc, 11, v10
    s_nop 1
    v_cndmask_b32 v47, v11, v47, vcc
    v_cmp_le_i32 vcc, 16, v10
    s_nop 1
    v_cndmask_b32 v48, v11, v48, vcc
    v_cmp_le_i32 vcc, 17, v10
    s_nop 1
    v_cndmask_b32 v49, v11, v49, vcc
    v_cmp_le_i32 vcc, 18, v10
    s_nop 1
    v_cndmask_b32 v50, v11, v50, vcc
    v_cmp_le_i32 vcc, 19, v10
    s_nop 1
    v_cndmask_b32 v51, v11, v51, vcc
    v_cmp_le_i32 vcc, 24, v10
    s_nop 1
    v_cndmask_b32 v52, v11, v52, vcc
    v_cmp_le_i32 vcc, 25, v10
    s_nop 1
    v_cndmask_b32 v53, v11, v53, vcc
    v_cmp_le_i32 vcc, 26, v10
    s_nop 1
    v_cndmask_b32 v54, v11, v54, vcc
    v_cmp_le_i32 vcc, 27, v10
    s_nop 1
    v_cndmask_b32 v55, v11, v55, vcc
    v_max3_f32 v13, v40, v41, v42
    v_max3_f32 v14, v43, v44, v45
    v_max3_f32 v15, v46, v47, v48
    v_max3_f32 v1, v49, v50, v51
    v_max3_f32 v13, v13, v52, v53
    v_max3_f32 v14, v14, v54, v55
    v_max3_f32 v15, v15, v1, v13
    v_max_f32 v13, v15, v14
    v_cmp_lt_f32 vcc, s40, v13
    s_cbranch_vccz k2_f_27
    v_mov_b32 v14, v13
    s_nop 1
    v_permlane32_swap_b32 v14, v13
    v_max_f32 v13, v13, v14
    v_max_f32 v14, 0, v13
    v_add_f32 v12, v12, v14
    v_sub_f32 v15, 0, v14
    v_exp_f32 v15, v15
    v_sub_f32 v40, v40, v14
    v_sub_f32 v24, v24, v14
    v_mul_f32 v80, v80, v15
    v_sub_f32 v41, v41, v14
    v_sub_f32 v25, v25, v14
    v_mul_f32 v81, v81, v15
    v_sub_f32 v42, v42, v14
    v_sub_f32 v26, v26, v14
    v_mul_f32 v82, v82, v15
    v_sub_f32 v43, v43, v14
    v_sub_f32 v27, v27, v14
    v_mul_f32 v83, v83, v15
    v_sub_f32 v44, v44, v14
    v_sub_f32 v28, v28, v14
    v_mul_f32 v84, v84, v15
    v_sub_f32 v45, v45, v14
    v_sub_f32 v29, v29, v14
    v_mul_f32 v85, v85, v15
    v_sub_f32 v46, v46, v14
    v_sub_f32 v30, v30, v14
    v_mul_f32 v86, v86, v15
    v_sub_f32 v47, v47, v14
    v_sub_f32 v31, v31, v14
    v_mul_f32 v87, v87, v15
    v_sub_f32 v48, v48, v14
    v_sub_f32 v32, v32, v14
    v_mul_f32 v88, v88, v15
    v_sub_f32 v49, v49, v14
    v_sub_f32 v33, v33, v14
    v_mul_f32 v89, v89, v15
    v_sub_f32 v50, v50, v14
    v_sub_f32 v34, v34, v14
    v_mul_f32 v90, v90, v15
    v_sub_f32 v51, v51, v14
    v_sub_f32 v35, v35, v14
    v_mul_f32 v91, v91, v15
    v_sub_f32 v52, v52, v14
    v_sub_f32 v36, v36, v14
    v_mul_f32 v92, v92, v15
    v_sub_f32 v53, v53, v14
    v_sub_f32 v37, v37, v14
    v_mul_f32 v93, v93, v15
    v_sub_f32 v54, v54, v14
    v_sub_f32 v38, v38, v14
    v_mul_f32 v94, v94, v15
    v_sub_f32 v55, v55, v14
    v_sub_f32 v39, v39, v14
    v_mul_f32 v95, v95, v15
    s_nop 1
k2_f_27:
    v_exp_f32 v40, v40
    v_exp_f32 v41, v41
    v_exp_f32 v42, v42
    v_exp_f32 v43, v43
    v_exp_f32 v44, v44
    v_exp_f32 v45, v45
    v_exp_f32 v46, v46
    v_exp_f32 v47, v47
    v_exp_f32 v48, v48
    v_exp_f32 v49, v49
    v_exp_f32 v50, v50
    v_exp_f32 v51, v51
    v_exp_f32 v52, v52
    v_exp_f32 v53, v53
    v_exp_f32 v54, v54
    v_exp_f32 v55, v55
    v_cvt_pk_bf16_f32 v72, v40, v41
    v_cvt_pk_bf16_f32 v73, v42, v43
    v_cvt_pk_bf16_f32 v74, v44, v45
    v_cvt_pk_bf16_f32 v75, v46, v47
    v_cvt_pk_bf16_f32 v76, v48, v49
    v_cvt_pk_bf16_f32 v77, v50, v51
    v_cvt_pk_bf16_f32 v78, v52, v53
    v_cvt_pk_bf16_f32 v79, v54, v55
    v_mfma_f32_32x32x16_bf16 v[80:95], v[104:107], v[72:75], v[80:95]
    s_nop 0
    v_mfma_f32_32x32x16_bf16 v[80:95], v[108:111], v[76:79], v[80:95]
    s_min_u32 s46, s28, 4
    s_mov_b32 s47, 0
    s_nop 9
    s_branch k2_bfull
k2_b1:
    s_cmp_lt_u32 s28, 5
    s_cbranch_scc1 k2_bempty
    v_subrev_u32 v124, 13120, v124
    v_subrev_u32 v125, 13120, v125
    v_subrev_u32 v126, 13120, v126
    ds_read_b128 v[96:99], v124 offset:0
    ds_read_b32 v100, v125 offset:0
    ds_read_b128 v[104:107], v126 offset:0
    ds_read_b128 v[108:111], v126 offset:672
    s_waitcnt lgkmcnt(0)
    v_mfma_f32_32x32x16_bf16 v[40:55], v[96:99], v[16:19], 0
    v_mfma_f32_32x32x16_bf16 v[40:55], v[100:103], v[20:23], v[40:55]
    s_nop 11
    v_max3_f32 v13, v40, v41, v42
    v_max3_f32 v14, v43, v44, v45
    v_max3_f32 v15, v46, v47, v48
    v_max3_f32 v1, v49, v50, v51
    v_max3_f32 v13, v13, v52, v53
    v_max3_f32 v14, v14, v54, v55
    v_max3_f32 v15, v15, v1, v13
    v_max_f32 v13, v15, v14
    v_mov_b32 v14, v13
    s_nop 1
    v_permlane32_swap_b32 v14, v13
    v_max_f32 v13, v13, v14
    v_mov_b32 v12, v13
    v_sub_f32 v24, 0, v13
    v_mov_b32 v80, 0
    v_sub_f32 v25, 0, v13
    v_mov_b32 v81, 0
    v_sub_f32 v26, 0, v13
    v_mov_b32 v82, 0
    v_sub_f32 v27, 0, v13
    v_mov_b32 v83, 0
    v_sub_f32 v28, 0, v13
    v_mov_b32 v84, 0
    v_sub_f32 v29, 0, v13
    v_mov_b32 v85, 0
    v_sub_f32 v30, 0, v13
    v_mov_b32 v86, 0
    v_sub_f32 v31, 0, v13
    v_mov_b32 v87, 0
    v_sub_f32 v32, 0, v13
    v_mov_b32 v88, 0
    v_sub_f32 v33, 0, v13
    v_mov_b32 v89, 0
    v_sub_f32 v34, 0, v13
    v_mov_b32 v90, 0
    v_sub_f32 v35, 0, v13
    v_mov_b32 v91, 0
    v_sub_f32 v36, 0, v13
    v_mov_b32 v92, 0
    v_sub_f32 v37, 0, v13
    v_mov_b32 v93, 0
    v_sub_f32 v38, 0, v13
    v_mov_b32 v94, 0
    v_sub_f32 v39, 0, v13
    v_mov_b32 v95, 0
    s_nop 0
    v_mfma_f32_32x32x16_bf16 v[40:55], v[96:99], v[16:19], v[24:39]
    v_mfma_f32_32x32x16_bf16 v[40:55], v[100:103], v[20:23], v[40:55]
    s_nop 11
    v_max3_f32 v13, v40, v41, v42
    v_max3_f32 v14, v43, v44, v45
    v_max3_f32 v15, v46, v47, v48
    v_max3_f32 v1, v49, v50, v51
    v_max3_f32 v13, v13, v52, v53
    v_max3_f32 v14, v14, v54, v55
    v_max3_f32 v15, v15, v1, v13
    v_max_f32 v13, v15, v14
    v_cmp_lt_f32 vcc, s40, v13
    s_cbranch_vccz k2_f_28
    v_mov_b32 v14, v13
    s_nop 1
    v_permlane32_swap_b32 v14, v13
    v_max_f32 v13, v13, v14
    v_max_f32 v14, 0, v13
    v_add_f32 v12, v12, v14
    v_sub_f32 v15, 0, v14
    v_exp_f32 v15, v15
    v_sub_f32 v40, v40, v14
    v_sub_f32 v24, v24, v14
    v_mul_f32 v80, v80, v15
    v_sub_f32 v41, v41, v14
    v_sub_f32 v25, v25, v14
    v_mul_f32 v81, v81, v15
    v_sub_f32 v42, v42, v14
    v_sub_f32 v26, v26, v14
    v_mul_f32 v82, v82, v15
    v_sub_f32 v43, v43, v14
    v_sub_f32 v27, v27, v14
    v_mul_f32 v83, v83, v15
    v_sub_f32 v44, v44, v14
    v_sub_f32 v28, v28, v14
    v_mul_f32 v84, v84, v15
    v_sub_f32 v45, v45, v14
    v_sub_f32 v29, v29, v14
    v_mul_f32 v85, v85, v15
    v_sub_f32 v46, v46, v14
    v_sub_f32 v30, v30, v14
    v_mul_f32 v86, v86, v15
    v_sub_f32 v47, v47, v14
    v_sub_f32 v31, v31, v14
    v_mul_f32 v87, v87, v15
    v_sub_f32 v48, v48, v14
    v_sub_f32 v32, v32, v14
    v_mul_f32 v88, v88, v15
    v_sub_f32 v49, v49, v14
    v_sub_f32 v33, v33, v14
    v_mul_f32 v89, v89, v15
    v_sub_f32 v50, v50, v14
    v_sub_f32 v34, v34, v14
    v_mul_f32 v90, v90, v15
    v_sub_f32 v51, v51, v14
    v_sub_f32 v35, v35, v14
    v_mul_f32 v91, v91, v15
    v_sub_f32 v52, v52, v14
    v_sub_f32 v36, v36, v14
    v_mul_f32 v92, v92, v15
    v_sub_f32 v53, v53, v14
    v_sub_f32 v37, v37, v14
    v_mul_f32 v93, v93, v15
    v_sub_f32 v54, v54, v14
    v_sub_f32 v38, v38, v14
    v_mul_f32 v94, v94, v15
    v_sub_f32 v55, v55, v14
    v_sub_f32 v39, v39, v14
    v_mul_f32 v95, v95, v15
    s_nop 1
k2_f_28:
    v_exp_f32 v40, v40
    v_exp_f32 v41, v41
    v_exp_f32 v42, v42
    v_exp_f32 v43, v43
    v_exp_f32 v44, v44
    v_exp_f32 v45, v45
    v_exp_f32 v46, v46
    v_exp_f32 v47, v47
    v_exp_f32 v48, v48
    v_exp_f32 v49, v49
    v_exp_f32 v50, v50
    v_exp_f32 v51, v51
    v_exp_f32 v52, v52
    v_exp_f32 v53, v53
    v_exp_f32 v54, v54
    v_exp_f32 v55, v55
    v_cvt_pk_bf16_f32 v72, v40, v41
    v_cvt_pk_bf16_f32 v73, v42, v43
    v_cvt_pk_bf16_f32 v74, v44, v45
    v_cvt_pk_bf16_f32 v75, v46, v47
    v_cvt_pk_bf16_f32 v76, v48, v49
    v_cvt_pk_bf16_f32 v77, v50, v51
    v_cvt_pk_bf16_f32 v78, v52, v53
    v_cvt_pk_bf16_f32 v79, v54, v55
    v_mfma_f32_32x32x16_bf16 v[80:95], v[104:107], v[72:75], v[80:95]
    s_nop 0
    v_mfma_f32_32x32x16_bf16 v[80:95], v[108:111], v[76:79], v[80:95]
    s_sub_u32 s46, s28, 5
    s_min_u32 s46, s46, 2
    s_cmp_ge_u32 s28, 8
    s_cselect_b32 s47, 1, 0
    s_nop 7
k2_bfull:
    s_cmp_eq_u32 s46, 0
    s_cbranch_scc1 k2_bfull_end
    v_subrev_u32 v124, 2624, v124
    v_subrev_u32 v125, 2624, v125
    v_subrev_u32 v126, 2624, v126
    ds_read_b128 v[96:99], v124 offset:0
    ds_read_b32 v100, v125 offset:0
    ds_read_b128 v[104:107], v126 offset:0
    ds_read_b128 v[108:111], v126 offset:672
    s_waitcnt lgkmcnt(2)
    v_mfma_f32_32x32x16_bf16 v[40:55], v[96:99], v[16:19], v[24:39]
    v_mfma_f32_32x32x16_bf16 v[40:55], v[100:103], v[20:23], v[40:55]
    s_nop 11
    v_max3_f32 v13, v40, v41, v42
    v_max3_f32 v14, v43, v44, v45
    v_max3_f32 v15, v46, v47, v48
    v_max3_f32 v1, v49, v50, v51
    v_max3_f32 v13, v13, v52, v53
    v_max3_f32 v14, v14, v54, v55
    v_max3_f32 v15, v15, v1, v13
    v_max_f32 v13, v15, v14
    v_cmp_lt_f32 vcc, s40, v13
    s_cbranch_vccz k2_f_29
    v_mov_b32 v14, v13
    s_nop 1
    v_permlane32_swap_b32 v14, v13
    v_max_f32 v13, v13, v14
    v_max_f32 v14, 0, v13
    v_add_f32 v12, v12, v14
    v_sub_f32 v15, 0, v14
    v_exp_f32 v15, v15
    v_sub_f32 v40, v40, v14
    v_sub_f32 v24, v24, v14
    v_mul_f32 v80, v80, v15
    v_sub_f32 v41, v41, v14
    v_sub_f32 v25, v25, v14
    v_mul_f32 v81, v81, v15
    v_sub_f32 v42, v42, v14
    v_sub_f32 v26, v26, v14
    v_mul_f32 v82, v82, v15
    v_sub_f32 v43, v43, v14
    v_sub_f32 v27, v27, v14
    v_mul_f32 v83, v83, v15
    v_sub_f32 v44, v44, v14
    v_sub_f32 v28, v28, v14
    v_mul_f32 v84, v84, v15
    v_sub_f32 v45, v45, v14
    v_sub_f32 v29, v29, v14
    v_mul_f32 v85, v85, v15
    v_sub_f32 v46, v46, v14
    v_sub_f32 v30, v30, v14
    v_mul_f32 v86, v86, v15
    v_sub_f32 v47, v47, v14
    v_sub_f32 v31, v31, v14
    v_mul_f32 v87, v87, v15
    v_sub_f32 v48, v48, v14
    v_sub_f32 v32, v32, v14
    v_mul_f32 v88, v88, v15
    v_sub_f32 v49, v49, v14
    v_sub_f32 v33, v33, v14
    v_mul_f32 v89, v89, v15
    v_sub_f32 v50, v50, v14
    v_sub_f32 v34, v34, v14
    v_mul_f32 v90, v90, v15
    v_sub_f32 v51, v51, v14
    v_sub_f32 v35, v35, v14
    v_mul_f32 v91, v91, v15
    v_sub_f32 v52, v52, v14
    v_sub_f32 v36, v36, v14
    v_mul_f32 v92, v92, v15
    v_sub_f32 v53, v53, v14
    v_sub_f32 v37, v37, v14
    v_mul_f32 v93, v93, v15
    v_sub_f32 v54, v54, v14
    v_sub_f32 v38, v38, v14
    v_mul_f32 v94, v94, v15
    v_sub_f32 v55, v55, v14
    v_sub_f32 v39, v39, v14
    v_mul_f32 v95, v95, v15
    s_nop 1
k2_f_29:
    s_waitcnt lgkmcnt(0)
    v_exp_f32 v40, v40
    v_exp_f32 v41, v41
    v_exp_f32 v42, v42
    v_exp_f32 v43, v43
    v_exp_f32 v44, v44
    v_exp_f32 v45, v45
    v_exp_f32 v46, v46
    v_exp_f32 v47, v47
    v_exp_f32 v48, v48
    v_exp_f32 v49, v49
    v_exp_f32 v50, v50
    v_exp_f32 v51, v51
    v_exp_f32 v52, v52
    v_exp_f32 v53, v53
    v_exp_f32 v54, v54
    v_exp_f32 v55, v55
    v_cvt_pk_bf16_f32 v72, v40, v41
    v_cvt_pk_bf16_f32 v73, v42, v43
    v_cvt_pk_bf16_f32 v74, v44, v45
    v_cvt_pk_bf16_f32 v75, v46, v47
    v_cvt_pk_bf16_f32 v76, v48, v49
    v_cvt_pk_bf16_f32 v77, v50, v51
    v_cvt_pk_bf16_f32 v78, v52, v53
    v_cvt_pk_bf16_f32 v79, v54, v55
    v_mfma_f32_32x32x16_bf16 v[80:95], v[104:107], v[72:75], v[80:95]
    s_nop 0
    v_mfma_f32_32x32x16_bf16 v[80:95], v[108:111], v[76:79], v[80:95]
    s_sub_u32 s46, s46, 1
    s_nop 10
    s_branch k2_bfull
k2_bfull_end:
    s_cmp_eq_u32 s47, 0
    s_cbranch_scc1 k2_bm
    v_subrev_u32 v124, 2624, v124
    v_subrev_u32 v125, 2624, v125
    v_subrev_u32 v126, 2624, v126
    ds_read_b128 v[96:99], v124 offset:0
    ds_read_b32 v100, v125 offset:0
    ds_read_b128 v[104:107], v126 offset:0
    ds_read_b128 v[108:111], v126 offset:672
    s_waitcnt lgkmcnt(0)
    v_mfma_f32_32x32x16_bf16 v[40:55], v[96:99], v[16:19], v[24:39]
    v_mfma_f32_32x32x16_bf16 v[40:55], v[100:103], v[20:23], v[40:55]
    v_cmp_gt_i32 vcc, 0, v10
    s_nop 10
    v_cndmask_b32 v40, v11, v40, vcc
    v_cmp_gt_i32 vcc, 1, v10
    s_nop 1
    v_cndmask_b32 v41, v11, v41, vcc
    v_cmp_gt_i32 vcc, 2, v10
    s_nop 1
    v_cndmask_b32 v42, v11, v42, vcc
    v_cmp_gt_i32 vcc, 3, v10
    s_nop 1
    v_cndmask_b32 v43, v11, v43, vcc
    v_cmp_gt_i32 vcc, 8, v10
    s_nop 1
    v_cndmask_b32 v44, v11, v44, vcc
    v_cmp_gt_i32 vcc, 9, v10
    s_nop 1
    v_cndmask_b32 v45, v11, v45, vcc
    v_cmp_gt_i32 vcc, 10, v10
    s_nop 1
    v_cndmask_b32 v46, v11, v46, vcc
    v_cmp_gt_i32 vcc, 11, v10
    s_nop 1
    v_cndmask_b32 v47, v11, v47, vcc
    v_cmp_gt_i32 vcc, 16, v10
    s_nop 1
    v_cndmask_b32 v48, v11, v48, vcc
    v_cmp_gt_i32 vcc, 17, v10
    s_nop 1
    v_cndmask_b32 v49, v11, v49, vcc
    v_cmp_gt_i32 vcc, 18, v10
    s_nop 1
    v_cndmask_b32 v50, v11, v50, vcc
    v_cmp_gt_i32 vcc, 19, v10
    s_nop 1
    v_cndmask_b32 v51, v11, v51, vcc
    v_cmp_gt_i32 vcc, 24, v10
    s_nop 1
    v_cndmask_b32 v52, v11, v52, vcc
    v_cmp_gt_i32 vcc, 25, v10
    s_nop 1
    v_cndmask_b32 v53, v11, v53, vcc
    v_cmp_gt_i32 vcc, 26, v10
    s_nop 1
    v_cndmask_b32 v54, v11, v54, vcc
    v_cmp_gt_i32 vcc, 27, v10
    s_nop 1
    v_cndmask_b32 v55, v11, v55, vcc
    v_max3_f32 v13, v40, v41, v42
    v_max3_f32 v14, v43, v44, v45
    v_max3_f32 v15, v46, v47, v48
    v_max3_f32 v1, v49, v50, v51
    v_max3_f32 v13, v13, v52, v53
    v_max3_f32 v14, v14, v54, v55
    v_max3_f32 v15, v15, v1, v13
    v_max_f32 v13, v15, v14
    v_cmp_lt_f32 vcc, s40, v13
    s_cbranch_vccz k2_f_30
    v_mov_b32 v14, v13
    s_nop 1
    v_permlane32_swap_b32 v14, v13
    v_max_f32 v13, v13, v14
    v_max_f32 v14, 0, v13
    v_add_f32 v12, v12, v14
    v_sub_f32 v15, 0, v14
    v_exp_f32 v15, v15
    v_sub_f32 v40, v40, v14
    v_sub_f32 v24, v24, v14
    v_mul_f32 v80, v80, v15
    v_sub_f32 v41, v41, v14
    v_sub_f32 v25, v25, v14
    v_mul_f32 v81, v81, v15
    v_sub_f32 v42, v42, v14
    v_sub_f32 v26, v26, v14
    v_mul_f32 v82, v82, v15
    v_sub_f32 v43, v43, v14
    v_sub_f32 v27, v27, v14
    v_mul_f32 v83, v83, v15
    v_sub_f32 v44, v44, v14
    v_sub_f32 v28, v28, v14
    v_mul_f32 v84, v84, v15
    v_sub_f32 v45, v45, v14
    v_sub_f32 v29, v29, v14
    v_mul_f32 v85, v85, v15
    v_sub_f32 v46, v46, v14
    v_sub_f32 v30, v30, v14
    v_mul_f32 v86, v86, v15
    v_sub_f32 v47, v47, v14
    v_sub_f32 v31, v31, v14
    v_mul_f32 v87, v87, v15
    v_sub_f32 v48, v48, v14
    v_sub_f32 v32, v32, v14
    v_mul_f32 v88, v88, v15
    v_sub_f32 v49, v49, v14
    v_sub_f32 v33, v33, v14
    v_mul_f32 v89, v89, v15
    v_sub_f32 v50, v50, v14
    v_sub_f32 v34, v34, v14
    v_mul_f32 v90, v90, v15
    v_sub_f32 v51, v51, v14
    v_sub_f32 v35, v35, v14
    v_mul_f32 v91, v91, v15
    v_sub_f32 v52, v52, v14
    v_sub_f32 v36, v36, v14
    v_mul_f32 v92, v92, v15
    v_sub_f32 v53, v53, v14
    v_sub_f32 v37, v37, v14
    v_mul_f32 v93, v93, v15
    v_sub_f32 v54, v54, v14
    v_sub_f32 v38, v38, v14
    v_mul_f32 v94, v94, v15
    v_sub_f32 v55, v55, v14
    v_sub_f32 v39, v39, v14
    v_mul_f32 v95, v95, v15
    s_nop 1
k2_f_30:
    v_exp_f32 v40, v40
    v_exp_f32 v41, v41
    v_exp_f32 v42, v42
    v_exp_f32 v43, v43
    v_exp_f32 v44, v44
    v_exp_f32 v45, v45
    v_exp_f32 v46, v46
    v_exp_f32 v47, v47
    v_exp_f32 v48, v48
    v_exp_f32 v49, v49
    v_exp_f32 v50, v50
    v_exp_f32 v51, v51
    v_exp_f32 v52, v52
    v_exp_f32 v53, v53
    v_exp_f32 v54, v54
    v_exp_f32 v55, v55
    v_cvt_pk_bf16_f32 v72, v40, v41
    v_cvt_pk_bf16_f32 v73, v42, v43
    v_cvt_pk_bf16_f32 v74, v44, v45
    v_cvt_pk_bf16_f32 v75, v46, v47
    v_cvt_pk_bf16_f32 v76, v48, v49
    v_cvt_pk_bf16_f32 v77, v50, v51
    v_cvt_pk_bf16_f32 v78, v52, v53
    v_cvt_pk_bf16_f32 v79, v54, v55
    v_mfma_f32_32x32x16_bf16 v[80:95], v[104:107], v[72:75], v[80:95]
    s_nop 0
    v_mfma_f32_32x32x16_bf16 v[80:95], v[108:111], v[76:79], v[80:95]
    s_nop 11
    s_branch k2_bm
k2_bempty:
    v_mov_b32 v12, v11
    v_mov_b32 v80, 0
    v_mov_b32 v81, 0
    v_mov_b32 v82, 0
    v_mov_b32 v83, 0
    v_mov_b32 v84, 0
    v_mov_b32 v85, 0
    v_mov_b32 v86, 0
    v_mov_b32 v87, 0
    v_mov_b32 v88, 0
    v_mov_b32 v89, 0
    v_mov_b32 v90, 0
    v_mov_b32 v91, 0
    s_nop 1
k2_bm:
    s_barrier
    s_and_b32 s44, s27, 7
    s_mul_i32 s44, s44, 3328
    s_add_u32 s44, s44, 0
    v_lshlrev_b32 v14, 2, v2
    v_add_u32 v14, s44, v14
    s_cmp_eq_u32 s33, 0
    s_nop 0
    s_cbranch_scc1 k2_g0_b
    ds_write_b32 v14, v80 offset:0
    ds_write_b32 v14, v81 offset:256
    ds_write_b32 v14, v82 offset:512
    ds_write_b32 v14, v83 offset:768
    ds_write_b32 v14, v84 offset:1024
    ds_write_b32 v14, v85 offset:1280
    ds_write_b32 v14, v86 offset:1536
    ds_write_b32 v14, v87 offset:1792
    ds_write_b32 v14, v88 offset:2048
    ds_write_b32 v14, v89 offset:2304
    ds_write_b32 v14, v90 offset:2560
    ds_write_b32 v14, v91 offset:2816
    ds_write_b32 v14, v12 offset:3072
    s_waitcnt lgkmcnt(0)
    s_barrier
    s_branch k2_md_b
k2_g0_b:
    s_barrier
    ds_read_b32 v40, v14 offset:0
    ds_read_b32 v41, v14 offset:256
    ds_read_b32 v42, v14 offset:512
    ds_read_b32 v43, v14 offset:768
    ds_read_b32 v44, v14 offset:1024
    ds_read_b32 v45, v14 offset:1280
    ds_read_b32 v46, v14 offset:1536
    ds_read_b32 v47, v14 offset:1792
    ds_read_b32 v48, v14 offset:2048
    ds_read_b32 v49, v14 offset:2304
    ds_read_b32 v50, v14 offset:2560
    ds_read_b32 v51, v14 offset:2816
    ds_read_b32 v52, v14 offset:3072
    s_waitcnt lgkmcnt(0)
    v_max_f32 v15, v12, v52
    v_sub_f32 v13, v12, v15
    v_sub_f32 v1, v52, v15
    v_exp_f32 v13, v13
    v_exp_f32 v1, v1
    v_mul_f32 v80, v80, v13
    v_fmac_f32 v80, v40, v1
    v_mul_f32 v81, v81, v13
    v_fmac_f32 v81, v41, v1
    v_mul_f32 v82, v82, v13
    v_fmac_f32 v82, v42, v1
    v_mul_f32 v83, v83, v13
    v_fmac_f32 v83, v43, v1
    v_mul_f32 v84, v84, v13
    v_fmac_f32 v84, v44, v1
    v_mul_f32 v85, v85, v13
    v_fmac_f32 v85, v45, v1
    v_mul_f32 v86, v86, v13
    v_fmac_f32 v86, v46, v1
    v_mul_f32 v87, v87, v13
    v_fmac_f32 v87, v47, v1
    v_mul_f32 v88, v88, v13
    v_fmac_f32 v88, v48, v1
    v_mul_f32 v89, v89, v13
    v_fmac_f32 v89, v49, v1
    v_mul_f32 v90, v90, v13
    v_fmac_f32 v90, v50, v1
    v_mul_f32 v91, v91, v13
    v_fmac_f32 v91, v51, v1
    v_mov_b32 v14, v88
    v_mov_b32 v15, v88
    s_nop 1
    v_permlane32_swap_b32 v14, v15
    v_rcp_f32 v15, v15
    s_nop 0
    v_mul_f32 v80, v80, v15
    v_mul_f32 v81, v81, v15
    v_mul_f32 v82, v82, v15
    v_mul_f32 v83, v83, v15
    v_mul_f32 v84, v84, v15
    v_mul_f32 v85, v85, v15
    v_mul_f32 v86, v86, v15
    v_mul_f32 v87, v87, v15
    v_mul_f32 v88, v88, v15
    v_mul_f32 v89, v89, v15
    v_mul_f32 v90, v90, v15
    v_mul_f32 v91, v91, v15
    v_cvt_pk_bf16_f32 v72, v80, v81
    v_cvt_pk_bf16_f32 v73, v82, v83
    v_cvt_pk_bf16_f32 v74, v84, v85
    v_cvt_pk_bf16_f32 v75, v86, v87
    v_cvt_pk_bf16_f32 v76, v88, v89
    v_cvt_pk_bf16_f32 v77, v90, v91
    s_lshl_b32 s43, s28, 5
    v_add_u32 v14, s43, v3
    s_movk_i32 s44, 1280
    v_mul_lo_u32 v14, v14, s44
    v_lshl_add_u32 v14, v4, 3, v14
    s_mul_i32 s44, s24, 40
    s_add_u32 s44, s44, 22020096
    buffer_store_dwordx2 v[72:73], v14, s[20:23], s44 offen
    buffer_store_dwordx2 v[74:75], v14, s[20:23], s44 offen offset:16
    s_mov_b32 exec_hi, 0
    buffer_store_dwordx2 v[76:77], v14, s[20:23], s44 offen offset:32
    s_mov_b64 exec, -1
k2_md_b:
k2_exit:
    s_endpgm
.globl oproj_kernel
.p2align 8
.type oproj_kernel,@function
oproj_kernel:
    s_cmp_ge_u32 s2, 320
    s_cbranch_scc1 k3_exit
    s_load_dwordx2 s[4:5], s[0:1], 16
    s_load_dwordx2 s[6:7], s[0:1], 40
    s_load_dwordx2 s[8:9], s[0:1], 56
    s_load_dwordx2 s[10:11], s[0:1], 72
    v_lshrrev_b32 v1, 6, v0
    s_nop 0
    v_readfirstlane_b32 s30, v1
    s_waitcnt lgkmcnt(0)
    s_nop 0
    s_lshr_b32 s33, s30, 2
    s_and_b32 s31, s30, 1
    s_bfe_u32 s32, s30, 0x10001
    s_cmp_eq_u32 s33, 0
    s_cselect_b32 s4, s4, s6
    s_cselect_b32 s5, s5, s7
    s_mov_b32 s34, 22020096
    s_cselect_b32 s34, 18874368, s34
    s_mov_b32 s12, s4
    s_and_b32 s13, s5, 0xffff
    s_mov_b32 s14, 0xc8000
    s_mov_b32 s15, 0x00020000
    s_mov_b32 s20, s10
    s_and_b32 s21, s11, 0xffff
    s_mov_b32 s22, 0x10000000
    s_mov_b32 s23, 0x00020000
    s_mov_b32 s24, s8
    s_and_b32 s25, s9, 0xffff
    s_mov_b32 s26, 0x280000
    s_mov_b32 s27, 0x00020000
    s_and_b32 s28, s2, 31
    s_lshr_b32 s29, s2, 5
    v_and_b32 v16, 255, v0
    s_lshl_b32 s35, s28, 6
    v_lshrrev_b32 v2, 3, v16
    v_add_u32 v2, s35, v2
    s_movk_i32 s36, 1280
    v_mul_lo_u32 v2, v2, s36
    v_and_b32 v3, 7, v16
    v_lshl_add_u32 v2, v3, 4, v2
    v_lshrrev_b32 v3, 3, v16
    v_mul_lo_u32 v3, v3, s36
    v_and_b32 v4, 7, v16
    v_lshl_add_u32 v3, v4, 4, v3
    s_lshl_b32 s37, s29, 7
    v_add_u32 v3, s37, v3
    s_mul_i32 s38, s33, 19456
    v_lshrrev_b32 v4, 3, v16
    v_mul_u32_u24 v5, 144, v4
    v_and_b32 v6, 7, v16
    v_lshl_add_u32 v5, v6, 4, v5
    v_add_u32 v5, s38, v5
    v_mul_u32_u24 v7, 160, v4
    v_lshl_add_u32 v7, v6, 4, v7
    v_add_u32 v7, s38, v7
    v_add_u32 v7, 9216, v7
    v_and_b32 v12, 63, v0
    v_and_b32 v13, 31, v12
    v_lshrrev_b32 v14, 5, v12
    s_lshl_b32 s39, s31, 5
    v_add_u32 v8, s39, v13
    v_mul_u32_u24 v8, 144, v8
    v_lshl_add_u32 v8, v14, 4, v8
    v_add_u32 v8, s38, v8
    v_and_b32 v15, 15, v12
    v_lshrrev_b32 v10, 2, v15
    v_lshl_add_u32 v10, v14, 3, v10
    v_mul_u32_u24 v10, 160, v10
    v_bfe_u32 v11, v12, 4, 1
    v_lshlrev_b32 v11, 4, v11
    v_and_b32 v15, 3, v15
    v_lshl_add_u32 v11, v15, 2, v11
    s_lshl_b32 s39, s32, 5
    v_add_u32 v11, s39, v11
    v_lshl_add_u32 v10, v11, 1, v10
    v_add_u32 v10, s38, v10
    v_add_u32 v10, 9216, v10
    s_lshl_b32 s39, s31, 5
    s_add_u32 s39, s39, s35
    v_add_u32 v48, s39, v13
    v_lshlrev_b32 v49, 2, v48
    s_mov_b32 s40, 25165824
    buffer_load_dword v50, v49, s[20:23], s40 offen
    v_mov_b32 v64, 0
    v_mov_b32 v65, 0
    v_mov_b32 v66, 0
    v_mov_b32 v67, 0
    v_mov_b32 v68, 0
    v_mov_b32 v69, 0
    v_mov_b32 v70, 0
    v_mov_b32 v71, 0
    v_mov_b32 v72, 0
    v_mov_b32 v73, 0
    v_mov_b32 v74, 0
    v_mov_b32 v75, 0
    v_mov_b32 v76, 0
    v_mov_b32 v77, 0
    v_mov_b32 v78, 0
    v_mov_b32 v79, 0
    s_mov_b32 s44, s34
    s_mov_b32 s45, 0
    buffer_load_dwordx4 v[96:99], v2, s[20:23], s44 offen
    s_add_u32 s46, s44, 40960
    buffer_load_dwordx4 v[100:103], v2, s[20:23], s46 offen
    buffer_load_dwordx4 v[104:107], v3, s[12:15], s45 offen
    s_add_u32 s46, s45, 40960
    buffer_load_dwordx4 v[108:111], v3, s[12:15], s46 offen
    s_add_u32 s44, s44, 128
    s_add_u32 s45, s45, 81920
    buffer_load_dwordx4 v[112:115], v2, s[20:23], s44 offen
    s_add_u32 s46, s44, 40960
    buffer_load_dwordx4 v[116:119], v2, s[20:23], s46 offen
    buffer_load_dwordx4 v[120:123], v3, s[12:15], s45 offen
    s_add_u32 s46, s45, 40960
    buffer_load_dwordx4 v[124:127], v3, s[12:15], s46 offen
    s_add_u32 s44, s44, 128
    s_add_u32 s45, s45, 81920
    s_waitcnt vmcnt(4)
    ds_write_b128 v5, v[96:99] offset:0
    ds_write_b128 v5, v[100:103] offset:4608
    ds_write_b128 v7, v[104:107] offset:0
    ds_write_b128 v7, v[108:111] offset:5120
    s_waitcnt lgkmcnt(0)
    s_barrier
    s_mov_b32 s48, 0
k3_loop:
    buffer_load_dwordx4 v[96:99], v2, s[20:23], s44 offen
    s_add_u32 s46, s44, 40960
    buffer_load_dwordx4 v[100:103], v2, s[20:23], s46 offen
    buffer_load_dwordx4 v[104:107], v3, s[12:15], s45 offen
    s_add_u32 s46, s45, 40960
    buffer_load_dwordx4 v[108:111], v3, s[12:15], s46 offen
    s_add_u32 s44, s44, 128
    s_add_u32 s45, s45, 81920
    ds_read_b128 v[16:19], v8 offset:0
    ds_read_b64_tr_b16 v[32:33], v10 offset:0
    ds_read_b64_tr_b16 v[34:35], v10 offset:640
    ds_read_b128 v[20:23], v8 offset:32
    ds_read_b64_tr_b16 v[36:37], v10 offset:2560
    ds_read_b64_tr_b16 v[38:39], v10 offset:3200
    ds_read_b128 v[24:27], v8 offset:64
    ds_read_b64_tr_b16 v[40:41], v10 offset:5120
    ds_read_b64_tr_b16 v[42:43], v10 offset:5760
    ds_read_b128 v[28:31], v8 offset:96
    ds_read_b64_tr_b16 v[44:45], v10 offset:7680
    ds_read_b64_tr_b16 v[46:47], v10 offset:8320
    s_waitcnt lgkmcnt(9)
    v_mfma_f32_32x32x16_bf16 v[64:79], v[32:35], v[16:19], v[64:79]
    s_waitcnt lgkmcnt(6)
    v_mfma_f32_32x32x16_bf16 v[64:79], v[36:39], v[20:23], v[64:79]
    s_waitcnt lgkmcnt(3)
    v_mfma_f32_32x32x16_bf16 v[64:79], v[40:43], v[24:27], v[64:79]
    s_waitcnt lgkmcnt(0)
    v_mfma_f32_32x32x16_bf16 v[64:79], v[44:47], v[28:31], v[64:79]
    s_waitcnt vmcnt(4)
    ds_write_b128 v5, v[112:115] offset:38912
    ds_write_b128 v5, v[116:119] offset:43520
    ds_write_b128 v7, v[120:123] offset:38912
    ds_write_b128 v7, v[124:127] offset:44032
    s_waitcnt lgkmcnt(0)
    s_barrier
    buffer_load_dwordx4 v[112:115], v2, s[20:23], s44 offen
    s_add_u32 s46, s44, 40960
    buffer_load_dwordx4 v[116:119], v2, s[20:23], s46 offen
    buffer_load_dwordx4 v[120:123], v3, s[12:15], s45 offen
    s_add_u32 s46, s45, 40960
    buffer_load_dwordx4 v[124:127], v3, s[12:15], s46 offen
    s_add_u32 s44, s44, 128
    s_add_u32 s45, s45, 81920
    ds_read_b128 v[16:19], v8 offset:38912
    ds_read_b64_tr_b16 v[32:33], v10 offset:38912
    ds_read_b64_tr_b16 v[34:35], v10 offset:39552
    ds_read_b128 v[20:23], v8 offset:38944
    ds_read_b64_tr_b16 v[36:37], v10 offset:41472
    ds_read_b64_tr_b16 v[38:39], v10 offset:42112
    ds_read_b128 v[24:27], v8 offset:38976
    ds_read_b64_tr_b16 v[40:41], v10 offset:44032
    ds_read_b64_tr_b16 v[42:43], v10 offset:44672
    ds_read_b128 v[28:31], v8 offset:39008
    ds_read_b64_tr_b16 v[44:45], v10 offset:46592
    ds_read_b64_tr_b16 v[46:47], v10 offset:47232
    s_waitcnt lgkmcnt(9)
    v_mfma_f32_32x32x16_bf16 v[64:79], v[32:35], v[16:19], v[64:79]
    s_waitcnt lgkmcnt(6)
    v_mfma_f32_32x32x16_bf16 v[64:79], v[36:39], v[20:23], v[64:79]
    s_waitcnt lgkmcnt(3)
    v_mfma_f32_32x32x16_bf16 v[64:79], v[40:43], v[24:27], v[64:79]
    s_waitcnt lgkmcnt(0)
    v_mfma_f32_32x32x16_bf16 v[64:79], v[44:47], v[28:31], v[64:79]
    s_waitcnt vmcnt(4)
    ds_write_b128 v5, v[96:99] offset:0
    ds_write_b128 v5, v[100:103] offset:4608
    ds_write_b128 v7, v[104:107] offset:0
    ds_write_b128 v7, v[108:111] offset:5120
    s_waitcnt lgkmcnt(0)
    s_barrier
    s_add_u32 s48, s48, 1
    s_cmp_lt_u32 s48, 4
    s_nop 2
    s_cbranch_scc1 k3_loop
    ds_read_b128 v[16:19], v8 offset:0
    ds_read_b64_tr_b16 v[32:33], v10 offset:0
    ds_read_b64_tr_b16 v[34:35], v10 offset:640
    ds_read_b128 v[20:23], v8 offset:32
    ds_read_b64_tr_b16 v[36:37], v10 offset:2560
    ds_read_b64_tr_b16 v[38:39], v10 offset:3200
    ds_read_b128 v[24:27], v8 offset:64
    ds_read_b64_tr_b16 v[40:41], v10 offset:5120
    ds_read_b64_tr_b16 v[42:43], v10 offset:5760
    ds_read_b128 v[28:31], v8 offset:96
    ds_read_b64_tr_b16 v[44:45], v10 offset:7680
    ds_read_b64_tr_b16 v[46:47], v10 offset:8320
    s_waitcnt lgkmcnt(9)
    v_mfma_f32_32x32x16_bf16 v[64:79], v[32:35], v[16:19], v[64:79]
    s_waitcnt lgkmcnt(6)
    v_mfma_f32_32x32x16_bf16 v[64:79], v[36:39], v[20:23], v[64:79]
    s_waitcnt lgkmcnt(3)
    v_mfma_f32_32x32x16_bf16 v[64:79], v[40:43], v[24:27], v[64:79]
    s_waitcnt lgkmcnt(0)
    v_mfma_f32_32x32x16_bf16 v[64:79], v[44:47], v[28:31], v[64:79]
    s_waitcnt vmcnt(0)
    ds_write_b128 v5, v[112:115] offset:38912
    ds_write_b128 v5, v[116:119] offset:43520
    ds_write_b128 v7, v[120:123] offset:38912
    ds_write_b128 v7, v[124:127] offset:44032
    s_waitcnt lgkmcnt(0)
    s_barrier
    ds_read_b128 v[16:19], v8 offset:38912
    ds_read_b64_tr_b16 v[32:33], v10 offset:38912
    ds_read_b64_tr_b16 v[34:35], v10 offset:39552
    ds_read_b128 v[20:23], v8 offset:38944
    ds_read_b64_tr_b16 v[36:37], v10 offset:41472
    ds_read_b64_tr_b16 v[38:39], v10 offset:42112
    ds_read_b128 v[24:27], v8 offset:38976
    ds_read_b64_tr_b16 v[40:41], v10 offset:44032
    ds_read_b64_tr_b16 v[42:43], v10 offset:44672
    ds_read_b128 v[28:31], v8 offset:39008
    ds_read_b64_tr_b16 v[44:45], v10 offset:46592
    ds_read_b64_tr_b16 v[46:47], v10 offset:47232
    s_waitcnt lgkmcnt(9)
    v_mfma_f32_32x32x16_bf16 v[64:79], v[32:35], v[16:19], v[64:79]
    s_waitcnt lgkmcnt(6)
    v_mfma_f32_32x32x16_bf16 v[64:79], v[36:39], v[20:23], v[64:79]
    s_waitcnt lgkmcnt(3)
    v_mfma_f32_32x32x16_bf16 v[64:79], v[40:43], v[24:27], v[64:79]
    s_waitcnt lgkmcnt(0)
    v_mfma_f32_32x32x16_bf16 v[64:79], v[44:47], v[28:31], v[64:79]
    s_barrier
    s_and_b32 s39, s30, 3
    s_lshl_b32 s39, s39, 12
    v_lshlrev_b32 v51, 2, v12
    v_add_u32 v51, s39, v51
    s_cmp_eq_u32 s33, 0
    s_nop 5
    s_cbranch_scc1 k3_p0
    ds_write_b32 v51, v64 offset:0
    ds_write_b32 v51, v65 offset:256
    ds_write_b32 v51, v66 offset:512
    ds_write_b32 v51, v67 offset:768
    ds_write_b32 v51, v68 offset:1024
    ds_write_b32 v51, v69 offset:1280
    ds_write_b32 v51, v70 offset:1536
    ds_write_b32 v51, v71 offset:1792
    ds_write_b32 v51, v72 offset:2048
    ds_write_b32 v51, v73 offset:2304
    ds_write_b32 v51, v74 offset:2560
    ds_write_b32 v51, v75 offset:2816
    ds_write_b32 v51, v76 offset:3072
    ds_write_b32 v51, v77 offset:3328
    ds_write_b32 v51, v78 offset:3584
    ds_write_b32 v51, v79 offset:3840
    s_waitcnt lgkmcnt(0)
    s_barrier
    s_branch k3_exit
k3_p0:
    s_barrier
    ds_read_b32 v80, v51 offset:0
    ds_read_b32 v81, v51 offset:256
    ds_read_b32 v82, v51 offset:512
    ds_read_b32 v83, v51 offset:768
    ds_read_b32 v84, v51 offset:1024
    ds_read_b32 v85, v51 offset:1280
    ds_read_b32 v86, v51 offset:1536
    ds_read_b32 v87, v51 offset:1792
    ds_read_b32 v88, v51 offset:2048
    ds_read_b32 v89, v51 offset:2304
    ds_read_b32 v90, v51 offset:2560
    ds_read_b32 v91, v51 offset:2816
    ds_read_b32 v92, v51 offset:3072
    ds_read_b32 v93, v51 offset:3328
    ds_read_b32 v94, v51 offset:3584
    ds_read_b32 v95, v51 offset:3840
    v_sub_f32 v53, 1.0, v50
    s_waitcnt lgkmcnt(0)
    v_mul_f32 v64, v50, v64
    v_fmac_f32 v64, v53, v80
    v_mul_f32 v65, v50, v65
    v_fmac_f32 v65, v53, v81
    v_mul_f32 v66, v50, v66
    v_fmac_f32 v66, v53, v82
    v_mul_f32 v67, v50, v67
    v_fmac_f32 v67, v53, v83
    v_mul_f32 v68, v50, v68
    v_fmac_f32 v68, v53, v84
    v_mul_f32 v69, v50, v69
    v_fmac_f32 v69, v53, v85
    v_mul_f32 v70, v50, v70
    v_fmac_f32 v70, v53, v86
    v_mul_f32 v71, v50, v71
    v_fmac_f32 v71, v53, v87
    v_mul_f32 v72, v50, v72
    v_fmac_f32 v72, v53, v88
    v_mul_f32 v73, v50, v73
    v_fmac_f32 v73, v53, v89
    v_mul_f32 v74, v50, v74
    v_fmac_f32 v74, v53, v90
    v_mul_f32 v75, v50, v75
    v_fmac_f32 v75, v53, v91
    v_mul_f32 v76, v50, v76
    v_fmac_f32 v76, v53, v92
    v_mul_f32 v77, v50, v77
    v_fmac_f32 v77, v53, v93
    v_mul_f32 v78, v50, v78
    v_fmac_f32 v78, v53, v94
    v_mul_f32 v79, v50, v79
    v_fmac_f32 v79, v53, v95
    s_movk_i32 s34, 1280
    v_mul_lo_u32 v52, v48, s34
    v_lshl_add_u32 v52, v14, 3, v52
    s_lshl_b32 s34, s29, 7
    s_lshl_b32 s35, s32, 6
    s_add_u32 s34, s34, s35
    v_cvt_pk_bf16_f32 v54, v64, v65
    v_cvt_pk_bf16_f32 v55, v66, v67
    buffer_store_dwordx2 v[54:55], v52, s[24:27], s34 offen offset:0
    v_cvt_pk_bf16_f32 v56, v68, v69
    v_cvt_pk_bf16_f32 v57, v70, v71
    buffer_store_dwordx2 v[56:57], v52, s[24:27], s34 offen offset:16
    v_cvt_pk_bf16_f32 v58, v72, v73
    v_cvt_pk_bf16_f32 v59, v74, v75
    buffer_store_dwordx2 v[58:59], v52, s[24:27], s34 offen offset:32
    v_cvt_pk_bf16_f32 v60, v76, v77
    v_cvt_pk_bf16_f32 v61, v78, v79
    buffer_store_dwordx2 v[60:61], v52, s[24:27], s34 offen offset:48
    s_nop 0
k3_exit:
    s_endpgm
.section .rodata,"a"
.p2align 6
.amdhsa_kernel qkv_kernel
  .amdhsa_next_free_vgpr 192
  .amdhsa_next_free_sgpr 102
  .amdhsa_accum_offset 192
  .amdhsa_group_segment_fixed_size 0
  .amdhsa_kernarg_size 80
  .amdhsa_user_sgpr_count 2
  .amdhsa_user_sgpr_kernarg_segment_ptr 1
  .amdhsa_system_sgpr_workgroup_id_x 1
.end_amdhsa_kernel
.p2align 6
.amdhsa_kernel attn_kernel
  .amdhsa_next_free_vgpr 128
  .amdhsa_next_free_sgpr 102
  .amdhsa_accum_offset 128
  .amdhsa_group_segment_fixed_size 0
  .amdhsa_kernarg_size 80
  .amdhsa_user_sgpr_count 2
  .amdhsa_user_sgpr_kernarg_segment_ptr 1
  .amdhsa_system_sgpr_workgroup_id_x 1
.end_amdhsa_kernel
.p2align 6
.amdhsa_kernel oproj_kernel
  .amdhsa_next_free_vgpr 128
  .amdhsa_next_free_sgpr 102
  .amdhsa_accum_offset 128
  .amdhsa_group_segment_fixed_size 0
  .amdhsa_kernarg_size 80
  .amdhsa_user_sgpr_count 2
  .amdhsa_user_sgpr_kernarg_segment_ptr 1
  .amdhsa_system_sgpr_workgroup_id_x 1
.end_amdhsa_kernel
```
